```python
import torch

def _softmax(x, axis=-1):
    return torch.softmax(x, dim=axis)
def _gelu(x):
    return torch.nn.functional.gelu(x, approximate="tanh")
def _silu(x):
    return torch.nn.functional.silu(x)
def _sigmoid(x):
    return torch.sigmoid(x)
def _layernorm(x, axis=-1, eps=1e-5):
    m = x.mean(dim=axis, keepdim=True)
    v = x.var(dim=axis, keepdim=True, unbiased=False)
    return (x - m) / torch.sqrt(v + eps)
def _scatter_add(tgt, idx, src, axis=0):
    return tgt.clone().index_add_(axis, idx, src)
def _segment_sum(src, seg, n):
    out = torch.zeros((n,) + src.shape[1:], dtype=src.dtype)
    return out.index_add_(0, seg, src)
def _pad(x, pw):
    flat = tuple(v for pair in reversed(pw) for v in pair)
    return torch.nn.functional.pad(x, flat)

kernel_name = 'parallel_sum__ssm_conv_s4__geglu_ffn__prompt'

def setup_inputs():

    _w = (lambda a: (lambda t: t.to(torch.bfloat16) if t.is_floating_point() else t)(torch.as_tensor(a)))
    def _A_setup():
        B, L, D, N = 1, 2048, 512, 128
        A_re = -(lambda _x: torch.exp(torch.as_tensor(_x)))((lambda *s: torch.randn(*s, dtype=torch.bfloat16) * 3.2)(D, N))
        A_im = torch.pi * (lambda *s: torch.randn(*s, dtype=torch.bfloat16) * 0.1)(D, N)
        B_re = (lambda *s: torch.randn(*s, dtype=torch.bfloat16) * 0.4)(D, N)
        B_im = (lambda *s: torch.randn(*s, dtype=torch.bfloat16) * 0.4)(D, N)
        C_re = (lambda *s: torch.randn(*s, dtype=torch.bfloat16) * 0.4)(D, N)
        C_im = (lambda *s: torch.randn(*s, dtype=torch.bfloat16) * 0.4)(D, N)
        log_dt = (lambda *s: torch.randn(*s, dtype=torch.bfloat16) * 0.1)(D) * 0.5 - 4.0
        Dskip = (lambda *s: torch.randn(*s, dtype=torch.bfloat16) * 0.2)(D)
        return {
            "u": _w((lambda *s: torch.randn(*s, dtype=torch.bfloat16) * 0.05)(B, L, D)),
            "A_re": _w(A_re),
            "A_im": _w(A_im),
            "B_re": _w(B_re),
            "B_im": _w(B_im),
            "C_re": _w(C_re),
            "C_im": _w(C_im),
            "log_dt": _w(log_dt),
            "Dskip": _w(Dskip),
        }
    _A_in = _A_setup()

    def _B_setup():
        B, S, D, F = 1, 2048, 512, 1376
        return {
            "x": _w((lambda *s: torch.randn(*s, dtype=torch.bfloat16) * 0.05)(B, S, D)),
            "w_gate": _w((lambda *s: torch.randn(*s, dtype=torch.bfloat16) * 0.05)(D, F)),
            "w_up": _w((lambda *s: torch.randn(*s, dtype=torch.bfloat16) * 0.05)(D, F)),
            "w_down": _w((lambda *s: torch.randn(*s, dtype=torch.bfloat16) * 0.05)(F, D)),
        }
    _B_in = _B_setup()

    return {
        "A_u": _A_in["u"],
        "A_A_re": _A_in["A_re"],
        "A_A_im": _A_in["A_im"],
        "A_B_re": _A_in["B_re"],
        "A_B_im": _A_in["B_im"],
        "A_C_re": _A_in["C_re"],
        "A_C_im": _A_in["C_im"],
        "A_log_dt": _A_in["log_dt"],
        "A_Dskip": _A_in["Dskip"],
        "B_x": _B_in["x"],
        "B_w_gate": _B_in["w_gate"],
        "B_w_up": _B_in["w_up"],
        "B_w_down": _B_in["w_down"],
    }

def reference(A_u, A_A_re, A_A_im, A_B_re, A_B_im, A_C_re, A_C_im, A_log_dt, A_Dskip, B_x, B_w_gate, B_w_up, B_w_down):
    def _A_ref(u, A_re, A_im, B_re, B_im, C_re, C_im, log_dt, Dskip):
        Bsz, L, D = u.shape
        dt = torch.exp(log_dt)[:, None]
        A = A_re + 1j * A_im
        Bc = B_re + 1j * B_im
        Cc = C_re + 1j * C_im
        logdA = dt * A
        dB = dt * Bc
        l = (lambda x, dt: x.to(dt))(torch.arange(L), A_re.dtype)
        P = torch.exp(logdA[:, :, None] * l[None, None, :])
        K = torch.einsum("dn,dnl,dn->dl", Cc, P, dB).real
        L2 = 2 * L
        Kp = _pad(K, ((0, 0), (0, L)))
        up = (lambda x, *d: x.permute(*d))(u, 0, 2, 1)
        up = _pad(up, ((0, 0), (0, 0), (0, L)))
        Kf = (lambda x, axes=(-2,-1): torch.fft.rfft2(x.float(), dim=axes))(Kp[:, None, :], axes=(-2, -1))
        Uf = (lambda x, axes=(-2,-1): torch.fft.rfft2(x.float(), dim=axes))(up[:, :, None, :], axes=(-2, -1))
        Yf = Uf * Kf[None, :, :, :]
        y = (lambda x, s, axes=(-2,-1): torch.fft.irfft2(x, s=s, dim=axes).to(torch.bfloat16))(Yf, (1, L2), axes=(-2, -1))[:, :, 0, :L]
        y = (lambda x, *d: x.permute(*d))(y, 0, 2, 1) + u * Dskip[None, None, :]
        return y

    def _B_ref(x, w_gate, w_up, w_down):
        return (_gelu(x @ w_gate) * (x @ w_up)) @ w_down

    x = A_u
    xn = _layernorm(x, axis=-1)
    return x + _A_ref(xn, A_A_re, A_A_im, A_B_re, A_B_im, A_C_re, A_C_im, A_log_dt, A_Dskip) + _B_ref(xn, B_w_gate, B_w_up, B_w_down)
```

```asm
; @launch grid=(256,1,1) block=(512,1,1) lds=163840
.amdgcn_target "amdgcn-amd-amdhsa--gfx950"
.text
.globl parallel_sum__ssm_conv_s4__geglu_ffn__prompt_kernel
.p2align 8
.type parallel_sum__ssm_conv_s4__geglu_ffn__prompt_kernel,@function
parallel_sum__ssm_conv_s4__geglu_ffn__prompt_kernel:
  s_cmp_ge_u32 s2, 256
  s_cbranch_scc1 L_end
  s_load_dwordx16 s[16:31], s[0:1], 0
  s_load_dwordx16 s[32:47], s[0:1], 64
  s_getpc_b64 s[74:75]
  s_lshr_b32 s11, s2, 3
  s_and_b32 s12, s11, 15
  s_lshl_b32 s12, s12, 11
  v_lshl_add_u32 v2, v0, 2, s12
  global_load_dword v175, v2, s[74:75]
  v_and_b32 v1, 63, v0
  v_lshrrev_b32 v3, 6, v0
  s_and_b32 s10, s2, 7
  v_readfirstlane_b32 s3, v3
  s_lshr_b32 s4, s10, 1
  s_lshl_b32 s4, s4, 2
  s_lshr_b32 s12, s11, 3
  s_add_u32 s4, s4, s12
  s_and_b32 s5, s10, 1
  s_lshl_b32 s5, s5, 3
  s_and_b32 s12, s11, 7
  s_add_u32 s5, s5, s12
  s_lshr_b32 s74, s3, 2
  s_and_b32 s3, s3, 3
  s_lshr_b32 s6, s3, 1
  s_and_b32 s7, s3, 1
  s_mul_i32 s8, s5, 3
  s_lshl_b32 s12, s5, 1
  s_add_u32 s12, s12, 11
  s_min_u32 s8, s8, s12
  s_cmp_lt_u32 s5, 11
  s_cselect_b32 s72, 6, 4
  s_lshr_b32 s73, s4, 3
  s_lshl_b32 s76, s10, 6
  s_lshl_b32 s11, s11, 1
  s_add_u32 s76, s76, s11
  s_add_u32 s76, s76, s6
  s_mov_b32 s77, s6
  s_mov_b32 s78, s7
  s_lshr_b32 s79, s5, 3
  s_and_b32 s80, s5, 7
  s_cmp_lg_u32 s74, 0
  s_cbranch_scc1 L_role_c

  s_setprio 1
  v_and_b32 v12, 31, v1
  v_lshrrev_b32 v13, 5, v1
  v_bfe_u32 v14, v12, 1, 3
  s_lshl_b32 s10, s6, 13
  v_lshl_add_u32 v15, v12, 7, s10
  v_add_u32 v11, 0, v13
  v_xor_b32 v11, v11, v14
  v_lshl_add_u32 v160, v11, 4, v15
  v_add_u32 v11, 2, v13
  v_xor_b32 v11, v11, v14
  v_lshl_add_u32 v161, v11, 4, v15
  v_add_u32 v11, 4, v13
  v_xor_b32 v11, v11, v14
  v_lshl_add_u32 v162, v11, 4, v15
  v_add_u32 v11, 6, v13
  v_xor_b32 v11, v11, v14
  v_lshl_add_u32 v163, v11, 4, v15
  v_lshrrev_b32 v12, 4, v1
  v_and_b32 v13, 1, v12
  v_lshrrev_b32 v12, 1, v12
  v_bfe_u32 v14, v1, 2, 2
  v_lshl_add_u32 v14, v12, 3, v14
  v_mul_u32_u24 v14, 192, v14
  v_and_b32 v15, 3, v1
  v_lshl_add_u32 v14, v15, 3, v14
  v_mul_u32_u24 v13, 12320, v13
  v_add_u32 v14, v14, v13
  s_mul_i32 s10, s7, 96
  s_add_u32 s10, s10, 16384
  v_add_u32 v164, s10, v14
  s_lshl_b32 s10, s4, 7
  s_lshl_b32 s11, s5, 3
  s_add_u32 s10, s10, s11
  s_lshl_b32 s11, s3, 1
  s_add_u32 s10, s10, s11
  s_lshl_b32 s10, s10, 10
  v_lshl_add_u32 v7, v1, 4, s10
  s_waitcnt lgkmcnt(0)
  s_mov_b32 s35, 0
  global_load_dwordx4 v[44:47], v7, s[16:17]
  global_load_dwordx4 v[48:51], v7, s[16:17] offset:1024
  v_mov_b32 v3, 0
  global_load_dword v6, v3, s[46:47] sc1
  s_waitcnt vmcnt(0)
  s_nop 0
  v_readfirstlane_b32 s34, v6
  s_nop 3
  s_mul_i32 s14, s34, 0x9e3779b1
  s_add_u32 s14, s14, 0x3c6ef373
  v_lshlrev_b32 v16, 16, v44
  v_and_b32 v17, 0xffff0000, v44
  v_lshlrev_b32 v18, 16, v45
  v_and_b32 v19, 0xffff0000, v45
  v_lshlrev_b32 v20, 16, v46
  v_and_b32 v21, 0xffff0000, v46
  v_lshlrev_b32 v22, 16, v47
  v_and_b32 v23, 0xffff0000, v47
  v_lshlrev_b32 v24, 16, v48
  v_and_b32 v25, 0xffff0000, v48
  v_lshlrev_b32 v26, 16, v49
  v_and_b32 v27, 0xffff0000, v49
  v_lshlrev_b32 v28, 16, v50
  v_and_b32 v29, 0xffff0000, v50
  v_lshlrev_b32 v30, 16, v51
  v_and_b32 v31, 0xffff0000, v51
  v_pk_add_f32 v[36:37], v[16:17], v[18:19]
  v_pk_mul_f32 v[38:39], v[16:17], v[16:17]
  v_pk_add_f32 v[40:41], v[24:25], v[26:27]
  v_pk_mul_f32 v[42:43], v[24:25], v[24:25]
  v_pk_add_f32 v[36:37], v[36:37], v[20:21]
  v_pk_fma_f32 v[38:39], v[18:19], v[18:19], v[38:39]
  v_pk_add_f32 v[40:41], v[40:41], v[28:29]
  v_pk_fma_f32 v[42:43], v[26:27], v[26:27], v[42:43]
  v_pk_add_f32 v[36:37], v[36:37], v[22:23]
  v_pk_fma_f32 v[38:39], v[20:21], v[20:21], v[38:39]
  v_pk_add_f32 v[40:41], v[40:41], v[30:31]
  v_pk_fma_f32 v[42:43], v[28:29], v[28:29], v[42:43]
  v_pk_fma_f32 v[38:39], v[22:23], v[22:23], v[38:39]
  v_add_f32 v32, v36, v37
  v_pk_fma_f32 v[42:43], v[30:31], v[30:31], v[42:43]
  v_add_f32 v33, v40, v41
  v_add_f32 v34, v38, v39
  v_add_f32 v35, v42, v43
  s_nop 0
  v_add_f32_dpp v32, v32, v32 quad_perm:[1,0,3,2] row_mask:0xf bank_mask:0xf
  v_add_f32_dpp v33, v33, v33 quad_perm:[1,0,3,2] row_mask:0xf bank_mask:0xf
  v_add_f32_dpp v34, v34, v34 quad_perm:[1,0,3,2] row_mask:0xf bank_mask:0xf
  v_add_f32_dpp v35, v35, v35 quad_perm:[1,0,3,2] row_mask:0xf bank_mask:0xf
  v_add_f32_dpp v32, v32, v32 quad_perm:[2,3,0,1] row_mask:0xf bank_mask:0xf
  v_add_f32_dpp v33, v33, v33 quad_perm:[2,3,0,1] row_mask:0xf bank_mask:0xf
  v_add_f32_dpp v34, v34, v34 quad_perm:[2,3,0,1] row_mask:0xf bank_mask:0xf
  v_add_f32_dpp v35, v35, v35 quad_perm:[2,3,0,1] row_mask:0xf bank_mask:0xf
  v_add_f32_dpp v32, v32, v32 row_half_mirror row_mask:0xf bank_mask:0xf
  v_add_f32_dpp v33, v33, v33 row_half_mirror row_mask:0xf bank_mask:0xf
  v_add_f32_dpp v34, v34, v34 row_half_mirror row_mask:0xf bank_mask:0xf
  v_add_f32_dpp v35, v35, v35 row_half_mirror row_mask:0xf bank_mask:0xf
  v_add_f32_dpp v32, v32, v32 row_mirror row_mask:0xf bank_mask:0xf
  v_add_f32_dpp v33, v33, v33 row_mirror row_mask:0xf bank_mask:0xf
  v_add_f32_dpp v34, v34, v34 row_mirror row_mask:0xf bank_mask:0xf
  v_add_f32_dpp v35, v35, v35 row_mirror row_mask:0xf bank_mask:0xf
  v_add_f32_dpp v32, v32, v32 row_bcast:15 row_mask:0xa bank_mask:0xf
  v_add_f32_dpp v33, v33, v33 row_bcast:15 row_mask:0xa bank_mask:0xf
  v_add_f32_dpp v34, v34, v34 row_bcast:15 row_mask:0xa bank_mask:0xf
  v_add_f32_dpp v35, v35, v35 row_bcast:15 row_mask:0xa bank_mask:0xf
  v_add_f32_dpp v32, v32, v32 row_bcast:31 row_mask:0xc bank_mask:0xf
  v_add_f32_dpp v33, v33, v33 row_bcast:31 row_mask:0xc bank_mask:0xf
  v_add_f32_dpp v34, v34, v34 row_bcast:31 row_mask:0xc bank_mask:0xf
  v_add_f32_dpp v35, v35, v35 row_bcast:31 row_mask:0xc bank_mask:0xf
  s_nop 1
  v_readlane_b32 s74, v32, 63
  v_readlane_b32 s75, v33, 63
  v_readlane_b32 s12, v34, 63
  v_readlane_b32 s13, v35, 63
  s_nop 1
  v_mov_b32 v32, s74
  v_mov_b32 v33, s75
  v_mov_b32 v34, s12
  v_mov_b32 v35, s13
  v_mov_b32 v36, 0x3b000000
  v_pk_mul_f32 v[32:33], v[32:33], v[36:37] op_sel_hi:[1,0]
  v_pk_mul_f32 v[34:35], v[34:35], v[36:37] op_sel_hi:[1,0]
  v_pk_fma_f32 v[34:35], v[32:33], v[32:33], v[34:35] neg_lo:[1,0,0] neg_hi:[1,0,0]
  v_max_f32 v34, 0, v34
  v_max_f32 v35, 0, v35
  v_cvt_pk_bf16_f32 v36, v34, v35
  v_cvt_pk_bf16_f32 v37, v32, v33
  v_lshlrev_b32 v34, 16, v36
  v_and_b32 v35, 0xffff0000, v36
  v_lshlrev_b32 v32, 16, v37
  v_and_b32 v33, 0xffff0000, v37
  v_add_f32 v34, 0x3727c5ac, v34
  v_add_f32 v35, 0x3727c5ac, v35
  v_cvt_pk_bf16_f32 v36, v34, v35
  v_lshlrev_b32 v34, 16, v36
  v_and_b32 v35, 0xffff0000, v36
  v_sqrt_f32 v34, v34
  v_sqrt_f32 v35, v35
  s_nop 0
  v_cvt_pk_bf16_f32 v36, v34, v35
  v_lshlrev_b32 v34, 16, v36
  v_and_b32 v35, 0xffff0000, v36
  v_rcp_f32 v34, v34
  v_rcp_f32 v35, v35
  v_pk_add_f32 v[16:17], v[16:17], v[32:33] op_sel_hi:[1,0] neg_lo:[0,1] neg_hi:[0,1]
  v_pk_add_f32 v[18:19], v[18:19], v[32:33] op_sel_hi:[1,0] neg_lo:[0,1] neg_hi:[0,1]
  v_pk_add_f32 v[20:21], v[20:21], v[32:33] op_sel_hi:[1,0] neg_lo:[0,1] neg_hi:[0,1]
  v_pk_add_f32 v[22:23], v[22:23], v[32:33] op_sel_hi:[1,0] neg_lo:[0,1] neg_hi:[0,1]
  v_pk_add_f32 v[24:25], v[24:25], v[32:33] op_sel:[0,1] op_sel_hi:[1,1] neg_lo:[0,1] neg_hi:[0,1]
  v_pk_add_f32 v[26:27], v[26:27], v[32:33] op_sel:[0,1] op_sel_hi:[1,1] neg_lo:[0,1] neg_hi:[0,1]
  v_pk_add_f32 v[28:29], v[28:29], v[32:33] op_sel:[0,1] op_sel_hi:[1,1] neg_lo:[0,1] neg_hi:[0,1]
  v_pk_add_f32 v[30:31], v[30:31], v[32:33] op_sel:[0,1] op_sel_hi:[1,1] neg_lo:[0,1] neg_hi:[0,1]
  v_cvt_pk_bf16_f32 v44, v16, v17
  v_cvt_pk_bf16_f32 v45, v18, v19
  v_cvt_pk_bf16_f32 v46, v20, v21
  v_cvt_pk_bf16_f32 v47, v22, v23
  v_cvt_pk_bf16_f32 v48, v24, v25
  v_cvt_pk_bf16_f32 v49, v26, v27
  v_cvt_pk_bf16_f32 v50, v28, v29
  v_cvt_pk_bf16_f32 v51, v30, v31
  v_lshlrev_b32 v16, 16, v44
  v_and_b32 v17, 0xffff0000, v44
  v_lshlrev_b32 v18, 16, v45
  v_and_b32 v19, 0xffff0000, v45
  v_lshlrev_b32 v20, 16, v46
  v_and_b32 v21, 0xffff0000, v46
  v_lshlrev_b32 v22, 16, v47
  v_and_b32 v23, 0xffff0000, v47
  v_lshlrev_b32 v24, 16, v48
  v_and_b32 v25, 0xffff0000, v48
  v_lshlrev_b32 v26, 16, v49
  v_and_b32 v27, 0xffff0000, v49
  v_lshlrev_b32 v28, 16, v50
  v_and_b32 v29, 0xffff0000, v50
  v_lshlrev_b32 v30, 16, v51
  v_and_b32 v31, 0xffff0000, v51
  v_pk_mul_f32 v[16:17], v[16:17], v[34:35] op_sel_hi:[1,0]
  v_pk_mul_f32 v[18:19], v[18:19], v[34:35] op_sel_hi:[1,0]
  v_pk_mul_f32 v[20:21], v[20:21], v[34:35] op_sel_hi:[1,0]
  v_pk_mul_f32 v[22:23], v[22:23], v[34:35] op_sel_hi:[1,0]
  v_pk_mul_f32 v[24:25], v[24:25], v[34:35] op_sel:[0,1] op_sel_hi:[1,1]
  v_pk_mul_f32 v[26:27], v[26:27], v[34:35] op_sel:[0,1] op_sel_hi:[1,1]
  v_pk_mul_f32 v[28:29], v[28:29], v[34:35] op_sel:[0,1] op_sel_hi:[1,1]
  v_pk_mul_f32 v[30:31], v[30:31], v[34:35] op_sel:[0,1] op_sel_hi:[1,1]
  v_cvt_pk_bf16_f32 v44, v16, v17
  v_cvt_pk_bf16_f32 v45, v18, v19
  v_cvt_pk_bf16_f32 v46, v20, v21
  v_cvt_pk_bf16_f32 v47, v22, v23
  v_cvt_pk_bf16_f32 v48, v24, v25
  v_cvt_pk_bf16_f32 v49, v26, v27
  v_cvt_pk_bf16_f32 v50, v28, v29
  v_cvt_pk_bf16_f32 v51, v30, v31
  s_mul_i32 s10, s3, 2176
  s_add_u32 s10, s10, 123648
  v_lshl_add_u32 v2, v1, 4, s10
  ds_write_b128 v2, v[44:47]
  ds_write_b128 v2, v[48:51] offset:1088
  v_mov_b32 v40, v34
  v_cvt_pk_bf16_f32 v41, -v32, -v32
  v_mov_b32 v42, v35
  v_cvt_pk_bf16_f32 v43, -v33, -v33
  s_lshl_b32 s10, s4, 7
  s_lshl_b32 s11, s5, 3
  s_add_u32 s10, s10, s11
  s_lshl_b32 s11, s3, 1
  s_add_u32 s11, s10, s11
  s_lshl_b32 s11, s11, 3
  s_add_u32 s11, s11, 65536
  v_mov_b32 v3, s11
  s_mov_b64 s[70:71], exec
  s_mov_b64 exec, 1
  global_store_dwordx4 v3, v[40:43], s[46:47] sc1
  s_mov_b64 exec, s[70:71]
  v_bfe_u32 v2, v1, 2, 2
  v_mul_u32_u24 v2, 1088, v2
  v_lshrrev_b32 v3, 4, v1
  v_lshl_add_u32 v2, v3, 5, v2
  v_and_b32 v3, 3, v1
  v_lshl_add_u32 v2, v3, 3, v2
  s_lshl_b32 s11, s3, 8
  s_add_u32 s11, s11, 123648
  v_add_u32 v2, s11, v2
  s_lshl_b32 s10, s10, 10
  s_lshl_b32 s11, s3, 11
  s_add_u32 s10, s10, s11
  s_add_u32 s10, s10, 1048576
  v_lshl_add_u32 v3, v1, 4, s10
  s_waitcnt lgkmcnt(0)
  s_barrier
  ds_read_b64_tr_b16 v[8:9], v2 offset:0
  ds_read_b64_tr_b16 v[10:11], v2 offset:4352
  ds_read_b64_tr_b16 v[12:13], v2 offset:128
  ds_read_b64_tr_b16 v[14:15], v2 offset:4480
  ds_read_b128 v[112:115], v160 offset:0
  ds_read_b128 v[116:119], v160 offset:4096
  ds_read_b64_tr_b16 v[120:121], v164 offset:0
  ds_read_b64_tr_b16 v[122:123], v164 offset:768
  ds_read_b64_tr_b16 v[124:125], v164 offset:32
  ds_read_b64_tr_b16 v[126:127], v164 offset:800
  ds_read_b64_tr_b16 v[128:129], v164 offset:64
  ds_read_b64_tr_b16 v[130:131], v164 offset:832
  s_waitcnt lgkmcnt(8)
  global_store_dwordx4 v3, v[8:11], s[46:47] sc1
  global_store_dwordx4 v3, v[12:15], s[46:47] offset:1024 sc1
  s_waitcnt lgkmcnt(0)
  v_mfma_f32_32x32x16_bf16 v[16:31], v[120:123], v[112:115], 0
  ds_read_b128 v[132:135], v161 offset:0
  ds_read_b128 v[136:139], v161 offset:4096
  ds_read_b64_tr_b16 v[140:141], v164 offset:3072
  v_mfma_f32_32x32x16_bf16 v[64:79], v[120:123], v[116:119], 0
  ds_read_b64_tr_b16 v[142:143], v164 offset:3840
  ds_read_b64_tr_b16 v[144:145], v164 offset:3104
  ds_read_b64_tr_b16 v[146:147], v164 offset:3872
  v_mfma_f32_32x32x16_bf16 v[32:47], v[124:127], v[112:115], 0
  ds_read_b64_tr_b16 v[148:149], v164 offset:3136
  ds_read_b64_tr_b16 v[150:151], v164 offset:3904
  v_mfma_f32_32x32x16_bf16 v[80:95], v[124:127], v[116:119], 0
  v_mfma_f32_32x32x16_bf16 v[48:63], v[128:131], v[112:115], 0
  v_mfma_f32_32x32x16_bf16 v[96:111], v[128:131], v[116:119], 0
  s_waitcnt lgkmcnt(0)
  v_mfma_f32_32x32x16_bf16 v[16:31], v[140:143], v[132:135], v[16:31]
  ds_read_b128 v[112:115], v162 offset:0
  ds_read_b128 v[116:119], v162 offset:4096
  ds_read_b64_tr_b16 v[120:121], v164 offset:6144
  v_mfma_f32_32x32x16_bf16 v[64:79], v[140:143], v[136:139], v[64:79]
  ds_read_b64_tr_b16 v[122:123], v164 offset:6912
  ds_read_b64_tr_b16 v[124:125], v164 offset:6176
  ds_read_b64_tr_b16 v[126:127], v164 offset:6944
  v_mfma_f32_32x32x16_bf16 v[32:47], v[144:147], v[132:135], v[32:47]
  ds_read_b64_tr_b16 v[128:129], v164 offset:6208
  ds_read_b64_tr_b16 v[130:131], v164 offset:6976
  v_mfma_f32_32x32x16_bf16 v[80:95], v[144:147], v[136:139], v[80:95]
  v_mfma_f32_32x32x16_bf16 v[48:63], v[148:151], v[132:135], v[48:63]
  v_mfma_f32_32x32x16_bf16 v[96:111], v[148:151], v[136:139], v[96:111]
  s_waitcnt lgkmcnt(0)
  v_mfma_f32_32x32x16_bf16 v[16:31], v[120:123], v[112:115], v[16:31]
  ds_read_b128 v[132:135], v163 offset:0
  ds_read_b128 v[136:139], v163 offset:4096
  ds_read_b64_tr_b16 v[140:141], v164 offset:9216
  v_mfma_f32_32x32x16_bf16 v[64:79], v[120:123], v[116:119], v[64:79]
  ds_read_b64_tr_b16 v[142:143], v164 offset:9984
  ds_read_b64_tr_b16 v[144:145], v164 offset:9248
  ds_read_b64_tr_b16 v[146:147], v164 offset:10016
  v_mfma_f32_32x32x16_bf16 v[32:47], v[124:127], v[112:115], v[32:47]
  ds_read_b64_tr_b16 v[148:149], v164 offset:9280
  ds_read_b64_tr_b16 v[150:151], v164 offset:10048
  v_mfma_f32_32x32x16_bf16 v[80:95], v[124:127], v[116:119], v[80:95]
  v_mfma_f32_32x32x16_bf16 v[48:63], v[128:131], v[112:115], v[48:63]
  v_mfma_f32_32x32x16_bf16 v[96:111], v[128:131], v[116:119], v[96:111]
  s_waitcnt lgkmcnt(0)
  v_mfma_f32_32x32x16_bf16 v[16:31], v[140:143], v[132:135], v[16:31]
  v_add_u32 v160, 41216, v160
  v_add_u32 v161, 41216, v161
  v_add_u32 v162, 41216, v162
  v_add_u32 v163, 41216, v163
  v_add_u32 v164, 41216, v164
  v_mfma_f32_32x32x16_bf16 v[64:79], v[140:143], v[136:139], v[64:79]
  s_barrier
  ds_read_b128 v[112:115], v160 offset:0
  ds_read_b128 v[116:119], v160 offset:4096
  ds_read_b64_tr_b16 v[120:121], v164 offset:0
  v_mfma_f32_32x32x16_bf16 v[32:47], v[144:147], v[132:135], v[32:47]
  ds_read_b64_tr_b16 v[122:123], v164 offset:768
  ds_read_b64_tr_b16 v[124:125], v164 offset:32
  ds_read_b64_tr_b16 v[126:127], v164 offset:800
  v_mfma_f32_32x32x16_bf16 v[80:95], v[144:147], v[136:139], v[80:95]
  ds_read_b64_tr_b16 v[128:129], v164 offset:64
  ds_read_b64_tr_b16 v[130:131], v164 offset:832
  v_mfma_f32_32x32x16_bf16 v[48:63], v[148:151], v[132:135], v[48:63]
  v_mfma_f32_32x32x16_bf16 v[96:111], v[148:151], v[136:139], v[96:111]
  s_waitcnt lgkmcnt(0)
  v_mfma_f32_32x32x16_bf16 v[16:31], v[120:123], v[112:115], v[16:31]
  ds_read_b128 v[132:135], v161 offset:0
  ds_read_b128 v[136:139], v161 offset:4096
  ds_read_b64_tr_b16 v[140:141], v164 offset:3072
  v_mfma_f32_32x32x16_bf16 v[64:79], v[120:123], v[116:119], v[64:79]
  ds_read_b64_tr_b16 v[142:143], v164 offset:3840
  ds_read_b64_tr_b16 v[144:145], v164 offset:3104
  ds_read_b64_tr_b16 v[146:147], v164 offset:3872
  v_mfma_f32_32x32x16_bf16 v[32:47], v[124:127], v[112:115], v[32:47]
  ds_read_b64_tr_b16 v[148:149], v164 offset:3136
  ds_read_b64_tr_b16 v[150:151], v164 offset:3904
  v_mfma_f32_32x32x16_bf16 v[80:95], v[124:127], v[116:119], v[80:95]
  v_mfma_f32_32x32x16_bf16 v[48:63], v[128:131], v[112:115], v[48:63]
  v_mfma_f32_32x32x16_bf16 v[96:111], v[128:131], v[116:119], v[96:111]
  s_waitcnt lgkmcnt(0)
  v_mfma_f32_32x32x16_bf16 v[16:31], v[140:143], v[132:135], v[16:31]
  ds_read_b128 v[112:115], v162 offset:0
  ds_read_b128 v[116:119], v162 offset:4096
  ds_read_b64_tr_b16 v[120:121], v164 offset:6144
  v_mfma_f32_32x32x16_bf16 v[64:79], v[140:143], v[136:139], v[64:79]
  ds_read_b64_tr_b16 v[122:123], v164 offset:6912
  ds_read_b64_tr_b16 v[124:125], v164 offset:6176
  ds_read_b64_tr_b16 v[126:127], v164 offset:6944
  v_mfma_f32_32x32x16_bf16 v[32:47], v[144:147], v[132:135], v[32:47]
  ds_read_b64_tr_b16 v[128:129], v164 offset:6208
  ds_read_b64_tr_b16 v[130:131], v164 offset:6976
  v_mfma_f32_32x32x16_bf16 v[80:95], v[144:147], v[136:139], v[80:95]
  v_mfma_f32_32x32x16_bf16 v[48:63], v[148:151], v[132:135], v[48:63]
  v_mfma_f32_32x32x16_bf16 v[96:111], v[148:151], v[136:139], v[96:111]
  s_waitcnt lgkmcnt(0)
  v_mfma_f32_32x32x16_bf16 v[16:31], v[120:123], v[112:115], v[16:31]
  ds_read_b128 v[132:135], v163 offset:0
  ds_read_b128 v[136:139], v163 offset:4096
  ds_read_b64_tr_b16 v[140:141], v164 offset:9216
  v_mfma_f32_32x32x16_bf16 v[64:79], v[120:123], v[116:119], v[64:79]
  ds_read_b64_tr_b16 v[142:143], v164 offset:9984
  ds_read_b64_tr_b16 v[144:145], v164 offset:9248
  ds_read_b64_tr_b16 v[146:147], v164 offset:10016
  v_mfma_f32_32x32x16_bf16 v[32:47], v[124:127], v[112:115], v[32:47]
  ds_read_b64_tr_b16 v[148:149], v164 offset:9280
  ds_read_b64_tr_b16 v[150:151], v164 offset:10048
  v_mfma_f32_32x32x16_bf16 v[80:95], v[124:127], v[116:119], v[80:95]
  v_mfma_f32_32x32x16_bf16 v[48:63], v[128:131], v[112:115], v[48:63]
  v_mfma_f32_32x32x16_bf16 v[96:111], v[128:131], v[116:119], v[96:111]
  s_waitcnt lgkmcnt(0)
  v_mfma_f32_32x32x16_bf16 v[16:31], v[140:143], v[132:135], v[16:31]
  v_add_u32 v160, 41216, v160
  v_add_u32 v161, 41216, v161
  v_add_u32 v162, 41216, v162
  v_add_u32 v163, 41216, v163
  v_add_u32 v164, 41216, v164
  v_mfma_f32_32x32x16_bf16 v[64:79], v[140:143], v[136:139], v[64:79]
  s_waitcnt vmcnt(0)
  s_barrier
  ds_read_b128 v[112:115], v160 offset:0
  ds_read_b128 v[116:119], v160 offset:4096
  ds_read_b64_tr_b16 v[120:121], v164 offset:0
  v_mfma_f32_32x32x16_bf16 v[32:47], v[144:147], v[132:135], v[32:47]
  ds_read_b64_tr_b16 v[122:123], v164 offset:768
  ds_read_b64_tr_b16 v[124:125], v164 offset:32
  ds_read_b64_tr_b16 v[126:127], v164 offset:800
  v_mfma_f32_32x32x16_bf16 v[80:95], v[144:147], v[136:139], v[80:95]
  ds_read_b64_tr_b16 v[128:129], v164 offset:64
  ds_read_b64_tr_b16 v[130:131], v164 offset:832
  v_mfma_f32_32x32x16_bf16 v[48:63], v[148:151], v[132:135], v[48:63]
  s_cmp_lg_u32 s3, 0
  s_cbranch_scc1 L_nofl_1
  s_mov_b32 s10, s2
  s_lshl_b32 s10, s10, 2
  s_add_u32 s10, s10, 4096
  v_mov_b32 v6, s10
  v_mov_b32 v7, s14
  s_mov_b64 s[70:71], exec
  s_mov_b64 exec, 1
  global_store_dword v6, v7, s[46:47] sc1
  s_mov_b64 exec, s[70:71]
L_nofl_1:
  v_mfma_f32_32x32x16_bf16 v[96:111], v[148:151], v[136:139], v[96:111]
  s_waitcnt lgkmcnt(0)
  v_mfma_f32_32x32x16_bf16 v[16:31], v[120:123], v[112:115], v[16:31]
  ds_read_b128 v[132:135], v161 offset:0
  ds_read_b128 v[136:139], v161 offset:4096
  ds_read_b64_tr_b16 v[140:141], v164 offset:3072
  v_mfma_f32_32x32x16_bf16 v[64:79], v[120:123], v[116:119], v[64:79]
  ds_read_b64_tr_b16 v[142:143], v164 offset:3840
  ds_read_b64_tr_b16 v[144:145], v164 offset:3104
  ds_read_b64_tr_b16 v[146:147], v164 offset:3872
  v_mfma_f32_32x32x16_bf16 v[32:47], v[124:127], v[112:115], v[32:47]
  ds_read_b64_tr_b16 v[148:149], v164 offset:3136
  ds_read_b64_tr_b16 v[150:151], v164 offset:3904
  v_mfma_f32_32x32x16_bf16 v[80:95], v[124:127], v[116:119], v[80:95]
  v_mfma_f32_32x32x16_bf16 v[48:63], v[128:131], v[112:115], v[48:63]
  v_mfma_f32_32x32x16_bf16 v[96:111], v[128:131], v[116:119], v[96:111]
  s_waitcnt lgkmcnt(0)
  v_mfma_f32_32x32x16_bf16 v[16:31], v[140:143], v[132:135], v[16:31]
  ds_read_b128 v[112:115], v162 offset:0
  ds_read_b128 v[116:119], v162 offset:4096
  ds_read_b64_tr_b16 v[120:121], v164 offset:6144
  v_mfma_f32_32x32x16_bf16 v[64:79], v[140:143], v[136:139], v[64:79]
  ds_read_b64_tr_b16 v[122:123], v164 offset:6912
  ds_read_b64_tr_b16 v[124:125], v164 offset:6176
  ds_read_b64_tr_b16 v[126:127], v164 offset:6944
  v_mfma_f32_32x32x16_bf16 v[32:47], v[144:147], v[132:135], v[32:47]
  ds_read_b64_tr_b16 v[128:129], v164 offset:6208
  ds_read_b64_tr_b16 v[130:131], v164 offset:6976
  v_mfma_f32_32x32x16_bf16 v[80:95], v[144:147], v[136:139], v[80:95]
  v_mfma_f32_32x32x16_bf16 v[48:63], v[148:151], v[132:135], v[48:63]
  v_mfma_f32_32x32x16_bf16 v[96:111], v[148:151], v[136:139], v[96:111]
  s_waitcnt lgkmcnt(0)
  v_mfma_f32_32x32x16_bf16 v[16:31], v[120:123], v[112:115], v[16:31]
  ds_read_b128 v[132:135], v163 offset:0
  ds_read_b128 v[136:139], v163 offset:4096
  ds_read_b64_tr_b16 v[140:141], v164 offset:9216
  v_mfma_f32_32x32x16_bf16 v[64:79], v[120:123], v[116:119], v[64:79]
  ds_read_b64_tr_b16 v[142:143], v164 offset:9984
  ds_read_b64_tr_b16 v[144:145], v164 offset:9248
  ds_read_b64_tr_b16 v[146:147], v164 offset:10016
  v_mfma_f32_32x32x16_bf16 v[32:47], v[124:127], v[112:115], v[32:47]
  ds_read_b64_tr_b16 v[148:149], v164 offset:9280
  ds_read_b64_tr_b16 v[150:151], v164 offset:10048
  v_mfma_f32_32x32x16_bf16 v[80:95], v[124:127], v[116:119], v[80:95]
  v_mfma_f32_32x32x16_bf16 v[48:63], v[128:131], v[112:115], v[48:63]
  v_mfma_f32_32x32x16_bf16 v[96:111], v[128:131], v[116:119], v[96:111]
  s_waitcnt lgkmcnt(0)
  v_mfma_f32_32x32x16_bf16 v[16:31], v[140:143], v[132:135], v[16:31]
  v_add_u32 v160, 4294884864, v160
  v_add_u32 v161, 4294884864, v161
  v_add_u32 v162, 4294884864, v162
  v_add_u32 v163, 4294884864, v163
  v_add_u32 v164, 4294884864, v164
  v_mfma_f32_32x32x16_bf16 v[64:79], v[140:143], v[136:139], v[64:79]
  s_barrier
  ds_read_b128 v[112:115], v160 offset:0
  ds_read_b128 v[116:119], v160 offset:4096
  ds_read_b64_tr_b16 v[120:121], v164 offset:0
  v_mfma_f32_32x32x16_bf16 v[32:47], v[144:147], v[132:135], v[32:47]
  ds_read_b64_tr_b16 v[122:123], v164 offset:768
  ds_read_b64_tr_b16 v[124:125], v164 offset:32
  ds_read_b64_tr_b16 v[126:127], v164 offset:800
  v_mfma_f32_32x32x16_bf16 v[80:95], v[144:147], v[136:139], v[80:95]
  ds_read_b64_tr_b16 v[128:129], v164 offset:64
  ds_read_b64_tr_b16 v[130:131], v164 offset:832
  v_mfma_f32_32x32x16_bf16 v[48:63], v[148:151], v[132:135], v[48:63]
  v_mfma_f32_32x32x16_bf16 v[96:111], v[148:151], v[136:139], v[96:111]
  s_waitcnt lgkmcnt(0)
  v_mfma_f32_32x32x16_bf16 v[16:31], v[120:123], v[112:115], v[16:31]
  ds_read_b128 v[132:135], v161 offset:0
  ds_read_b128 v[136:139], v161 offset:4096
  ds_read_b64_tr_b16 v[140:141], v164 offset:3072
  v_mfma_f32_32x32x16_bf16 v[64:79], v[120:123], v[116:119], v[64:79]
  ds_read_b64_tr_b16 v[142:143], v164 offset:3840
  ds_read_b64_tr_b16 v[144:145], v164 offset:3104
  ds_read_b64_tr_b16 v[146:147], v164 offset:3872
  v_mfma_f32_32x32x16_bf16 v[32:47], v[124:127], v[112:115], v[32:47]
  ds_read_b64_tr_b16 v[148:149], v164 offset:3136
  ds_read_b64_tr_b16 v[150:151], v164 offset:3904
  v_mfma_f32_32x32x16_bf16 v[80:95], v[124:127], v[116:119], v[80:95]
  v_mfma_f32_32x32x16_bf16 v[48:63], v[128:131], v[112:115], v[48:63]
  v_mfma_f32_32x32x16_bf16 v[96:111], v[128:131], v[116:119], v[96:111]
  s_waitcnt lgkmcnt(0)
  v_mfma_f32_32x32x16_bf16 v[16:31], v[140:143], v[132:135], v[16:31]
  ds_read_b128 v[112:115], v162 offset:0
  ds_read_b128 v[116:119], v162 offset:4096
  ds_read_b64_tr_b16 v[120:121], v164 offset:6144
  v_mfma_f32_32x32x16_bf16 v[64:79], v[140:143], v[136:139], v[64:79]
  ds_read_b64_tr_b16 v[122:123], v164 offset:6912
  ds_read_b64_tr_b16 v[124:125], v164 offset:6176
  ds_read_b64_tr_b16 v[126:127], v164 offset:6944
  v_mfma_f32_32x32x16_bf16 v[32:47], v[144:147], v[132:135], v[32:47]
  ds_read_b64_tr_b16 v[128:129], v164 offset:6208
  ds_read_b64_tr_b16 v[130:131], v164 offset:6976
  v_mfma_f32_32x32x16_bf16 v[80:95], v[144:147], v[136:139], v[80:95]
  v_mfma_f32_32x32x16_bf16 v[48:63], v[148:151], v[132:135], v[48:63]
  v_mfma_f32_32x32x16_bf16 v[96:111], v[148:151], v[136:139], v[96:111]
  s_waitcnt lgkmcnt(0)
  v_mfma_f32_32x32x16_bf16 v[16:31], v[120:123], v[112:115], v[16:31]
  ds_read_b128 v[132:135], v163 offset:0
  ds_read_b128 v[136:139], v163 offset:4096
  ds_read_b64_tr_b16 v[140:141], v164 offset:9216
  v_mfma_f32_32x32x16_bf16 v[64:79], v[120:123], v[116:119], v[64:79]
  ds_read_b64_tr_b16 v[142:143], v164 offset:9984
  ds_read_b64_tr_b16 v[144:145], v164 offset:9248
  ds_read_b64_tr_b16 v[146:147], v164 offset:10016
  v_mfma_f32_32x32x16_bf16 v[32:47], v[124:127], v[112:115], v[32:47]
  ds_read_b64_tr_b16 v[148:149], v164 offset:9280
  ds_read_b64_tr_b16 v[150:151], v164 offset:10048
  v_mfma_f32_32x32x16_bf16 v[80:95], v[124:127], v[116:119], v[80:95]
  v_mfma_f32_32x32x16_bf16 v[48:63], v[128:131], v[112:115], v[48:63]
  v_mfma_f32_32x32x16_bf16 v[96:111], v[128:131], v[116:119], v[96:111]
  s_waitcnt lgkmcnt(0)
  v_mfma_f32_32x32x16_bf16 v[16:31], v[140:143], v[132:135], v[16:31]
  v_add_u32 v160, 41216, v160
  v_add_u32 v161, 41216, v161
  v_add_u32 v162, 41216, v162
  v_add_u32 v163, 41216, v163
  v_add_u32 v164, 41216, v164
  v_mfma_f32_32x32x16_bf16 v[64:79], v[140:143], v[136:139], v[64:79]
  s_barrier
  ds_read_b128 v[112:115], v160 offset:0
  ds_read_b128 v[116:119], v160 offset:4096
  ds_read_b64_tr_b16 v[120:121], v164 offset:0
  v_mfma_f32_32x32x16_bf16 v[32:47], v[144:147], v[132:135], v[32:47]
  ds_read_b64_tr_b16 v[122:123], v164 offset:768
  ds_read_b64_tr_b16 v[124:125], v164 offset:32
  ds_read_b64_tr_b16 v[126:127], v164 offset:800
  v_mfma_f32_32x32x16_bf16 v[80:95], v[144:147], v[136:139], v[80:95]
  ds_read_b64_tr_b16 v[128:129], v164 offset:64
  ds_read_b64_tr_b16 v[130:131], v164 offset:832
  v_mfma_f32_32x32x16_bf16 v[48:63], v[148:151], v[132:135], v[48:63]
  v_mfma_f32_32x32x16_bf16 v[96:111], v[148:151], v[136:139], v[96:111]
  s_waitcnt lgkmcnt(0)
  v_mfma_f32_32x32x16_bf16 v[16:31], v[120:123], v[112:115], v[16:31]
  ds_read_b128 v[132:135], v161 offset:0
  ds_read_b128 v[136:139], v161 offset:4096
  ds_read_b64_tr_b16 v[140:141], v164 offset:3072
  v_mfma_f32_32x32x16_bf16 v[64:79], v[120:123], v[116:119], v[64:79]
  ds_read_b64_tr_b16 v[142:143], v164 offset:3840
  ds_read_b64_tr_b16 v[144:145], v164 offset:3104
  ds_read_b64_tr_b16 v[146:147], v164 offset:3872
  v_mfma_f32_32x32x16_bf16 v[32:47], v[124:127], v[112:115], v[32:47]
  ds_read_b64_tr_b16 v[148:149], v164 offset:3136
  ds_read_b64_tr_b16 v[150:151], v164 offset:3904
  v_mfma_f32_32x32x16_bf16 v[80:95], v[124:127], v[116:119], v[80:95]
  v_mfma_f32_32x32x16_bf16 v[48:63], v[128:131], v[112:115], v[48:63]
  v_mfma_f32_32x32x16_bf16 v[96:111], v[128:131], v[116:119], v[96:111]
  s_waitcnt lgkmcnt(0)
  v_mfma_f32_32x32x16_bf16 v[16:31], v[140:143], v[132:135], v[16:31]
  ds_read_b128 v[112:115], v162 offset:0
  ds_read_b128 v[116:119], v162 offset:4096
  ds_read_b64_tr_b16 v[120:121], v164 offset:6144
  v_mfma_f32_32x32x16_bf16 v[64:79], v[140:143], v[136:139], v[64:79]
  ds_read_b64_tr_b16 v[122:123], v164 offset:6912
  ds_read_b64_tr_b16 v[124:125], v164 offset:6176
  ds_read_b64_tr_b16 v[126:127], v164 offset:6944
  v_mfma_f32_32x32x16_bf16 v[32:47], v[144:147], v[132:135], v[32:47]
  ds_read_b64_tr_b16 v[128:129], v164 offset:6208
  ds_read_b64_tr_b16 v[130:131], v164 offset:6976
  s_mov_b32 s60, s40
  s_and_b32 s61, s41, 0xffff
  s_mov_b32 s62, 1409024
  s_mov_b32 s63, 0x20000
  s_mul_i32 s81, s3, 360448
  s_lshl_b32 s10, s80, 7
  s_add_u32 s81, s81, s10
  v_mfma_f32_32x32x16_bf16 v[80:95], v[144:147], v[136:139], v[80:95]
  v_lshrrev_b32 v6, 3, v1
  v_and_b32 v7, 7, v1
  v_bfe_u32 v8, v6, 1, 1
  v_lshlrev_b32 v8, 2, v8
  v_xor_b32 v7, v7, v8
  v_lshlrev_b32 v7, 4, v7
  v_lshl_add_u32 v172, v6, 10, v7
  v_mfma_f32_32x32x16_bf16 v[48:63], v[148:151], v[132:135], v[48:63]
  v_lshrrev_b32 v6, 4, v1
  v_and_b32 v7, 1, v6
  v_lshrrev_b32 v6, 1, v6
  v_bfe_u32 v8, v1, 2, 2
  v_lshl_add_u32 v8, v6, 2, v8
  v_lshlrev_b32 v8, 7, v8
  v_lshl_add_u32 v8, v7, 5, v8
  v_mfma_f32_32x32x16_bf16 v[96:111], v[148:151], v[136:139], v[96:111]
  v_and_b32 v7, 3, v1
  v_lshl_add_u32 v8, v7, 3, v8
  v_bfe_u32 v7, v1, 3, 1
  v_lshlrev_b32 v7, 6, v7
  v_add_u32 v173, v8, v7
  v_xor_b32 v7, 64, v7
  v_add_u32 v174, v8, v7
  s_waitcnt lgkmcnt(0)
  v_mfma_f32_32x32x16_bf16 v[16:31], v[120:123], v[112:115], v[16:31]
  ds_read_b128 v[132:135], v163 offset:0
  ds_read_b128 v[136:139], v163 offset:4096
  ds_read_b64_tr_b16 v[140:141], v164 offset:9216
  v_mfma_f32_32x32x16_bf16 v[64:79], v[120:123], v[116:119], v[64:79]
  ds_read_b64_tr_b16 v[142:143], v164 offset:9984
  ds_read_b64_tr_b16 v[144:145], v164 offset:9248
  ds_read_b64_tr_b16 v[146:147], v164 offset:10016
  v_mfma_f32_32x32x16_bf16 v[32:47], v[124:127], v[112:115], v[32:47]
  ds_read_b64_tr_b16 v[148:149], v164 offset:9280
  ds_read_b64_tr_b16 v[150:151], v164 offset:10048
  v_mfma_f32_32x32x16_bf16 v[80:95], v[124:127], v[116:119], v[80:95]
  v_mfma_f32_32x32x16_bf16 v[48:63], v[128:131], v[112:115], v[48:63]
  v_mfma_f32_32x32x16_bf16 v[96:111], v[128:131], v[116:119], v[96:111]
  s_waitcnt lgkmcnt(0)
  v_mfma_f32_32x32x16_bf16 v[16:31], v[140:143], v[132:135], v[16:31]
  v_add_u32 v160, 41216, v160
  v_add_u32 v161, 41216, v161
  v_add_u32 v162, 41216, v162
  v_add_u32 v163, 41216, v163
  v_add_u32 v164, 41216, v164
  v_mfma_f32_32x32x16_bf16 v[64:79], v[140:143], v[136:139], v[64:79]
  s_barrier
  ds_read_b128 v[112:115], v160 offset:0
  ds_read_b128 v[116:119], v160 offset:4096
  ds_read_b64_tr_b16 v[120:121], v164 offset:0
  v_mfma_f32_32x32x16_bf16 v[32:47], v[144:147], v[132:135], v[32:47]
  ds_read_b64_tr_b16 v[122:123], v164 offset:768
  ds_read_b64_tr_b16 v[124:125], v164 offset:32
  ds_read_b64_tr_b16 v[126:127], v164 offset:800
  v_mfma_f32_32x32x16_bf16 v[80:95], v[144:147], v[136:139], v[80:95]
  ds_read_b64_tr_b16 v[128:129], v164 offset:64
  ds_read_b64_tr_b16 v[130:131], v164 offset:832
  v_mfma_f32_32x32x16_bf16 v[48:63], v[148:151], v[132:135], v[48:63]
  v_mfma_f32_32x32x16_bf16 v[96:111], v[148:151], v[136:139], v[96:111]
  s_waitcnt lgkmcnt(0)
  v_mfma_f32_32x32x16_bf16 v[16:31], v[120:123], v[112:115], v[16:31]
  ds_read_b128 v[132:135], v161 offset:0
  ds_read_b128 v[136:139], v161 offset:4096
  ds_read_b64_tr_b16 v[140:141], v164 offset:3072
  v_mfma_f32_32x32x16_bf16 v[64:79], v[120:123], v[116:119], v[64:79]
  ds_read_b64_tr_b16 v[142:143], v164 offset:3840
  ds_read_b64_tr_b16 v[144:145], v164 offset:3104
  ds_read_b64_tr_b16 v[146:147], v164 offset:3872
  v_mfma_f32_32x32x16_bf16 v[32:47], v[124:127], v[112:115], v[32:47]
  ds_read_b64_tr_b16 v[148:149], v164 offset:3136
  ds_read_b64_tr_b16 v[150:151], v164 offset:3904
  v_mfma_f32_32x32x16_bf16 v[80:95], v[124:127], v[116:119], v[80:95]
  v_mfma_f32_32x32x16_bf16 v[48:63], v[128:131], v[112:115], v[48:63]
  v_mfma_f32_32x32x16_bf16 v[96:111], v[128:131], v[116:119], v[96:111]
  s_waitcnt lgkmcnt(0)
  v_mfma_f32_32x32x16_bf16 v[16:31], v[140:143], v[132:135], v[16:31]
  ds_read_b128 v[112:115], v162 offset:0
  ds_read_b128 v[116:119], v162 offset:4096
  ds_read_b64_tr_b16 v[120:121], v164 offset:6144
  v_mfma_f32_32x32x16_bf16 v[64:79], v[140:143], v[136:139], v[64:79]
  ds_read_b64_tr_b16 v[122:123], v164 offset:6912
  ds_read_b64_tr_b16 v[124:125], v164 offset:6176
  ds_read_b64_tr_b16 v[126:127], v164 offset:6944
  v_mfma_f32_32x32x16_bf16 v[32:47], v[144:147], v[132:135], v[32:47]
  ds_read_b64_tr_b16 v[128:129], v164 offset:6208
  ds_read_b64_tr_b16 v[130:131], v164 offset:6976
  v_mfma_f32_32x32x16_bf16 v[80:95], v[144:147], v[136:139], v[80:95]
  v_mfma_f32_32x32x16_bf16 v[48:63], v[148:151], v[132:135], v[48:63]
  v_mfma_f32_32x32x16_bf16 v[96:111], v[148:151], v[136:139], v[96:111]
  s_waitcnt lgkmcnt(0)
  v_mfma_f32_32x32x16_bf16 v[16:31], v[120:123], v[112:115], v[16:31]
  ds_read_b128 v[132:135], v163 offset:0
  ds_read_b128 v[136:139], v163 offset:4096
  ds_read_b64_tr_b16 v[140:141], v164 offset:9216
  v_mfma_f32_32x32x16_bf16 v[64:79], v[120:123], v[116:119], v[64:79]
  ds_read_b64_tr_b16 v[142:143], v164 offset:9984
  ds_read_b64_tr_b16 v[144:145], v164 offset:9248
  ds_read_b64_tr_b16 v[146:147], v164 offset:10016
  v_mfma_f32_32x32x16_bf16 v[32:47], v[124:127], v[112:115], v[32:47]
  ds_read_b64_tr_b16 v[148:149], v164 offset:9280
  ds_read_b64_tr_b16 v[150:151], v164 offset:10048
  v_mfma_f32_32x32x16_bf16 v[80:95], v[124:127], v[116:119], v[80:95]
  v_mfma_f32_32x32x16_bf16 v[48:63], v[128:131], v[112:115], v[48:63]
  v_mfma_f32_32x32x16_bf16 v[96:111], v[128:131], v[116:119], v[96:111]
  s_waitcnt lgkmcnt(0)
  v_mfma_f32_32x32x16_bf16 v[16:31], v[140:143], v[132:135], v[16:31]
  v_add_u32 v160, 4294884864, v160
  v_add_u32 v161, 4294884864, v161
  v_add_u32 v162, 4294884864, v162
  v_add_u32 v163, 4294884864, v163
  v_add_u32 v164, 4294884864, v164
  v_mfma_f32_32x32x16_bf16 v[64:79], v[140:143], v[136:139], v[64:79]
  s_barrier
  ds_read_b128 v[112:115], v160 offset:0
  ds_read_b128 v[116:119], v160 offset:4096
  ds_read_b64_tr_b16 v[120:121], v164 offset:0
  v_mfma_f32_32x32x16_bf16 v[32:47], v[144:147], v[132:135], v[32:47]
  ds_read_b64_tr_b16 v[122:123], v164 offset:768
  ds_read_b64_tr_b16 v[124:125], v164 offset:32
  ds_read_b64_tr_b16 v[126:127], v164 offset:800
  v_mfma_f32_32x32x16_bf16 v[80:95], v[144:147], v[136:139], v[80:95]
  ds_read_b64_tr_b16 v[128:129], v164 offset:64
  ds_read_b64_tr_b16 v[130:131], v164 offset:832
  v_mfma_f32_32x32x16_bf16 v[48:63], v[148:151], v[132:135], v[48:63]
  v_lshlrev_b32 v165, 4, v1
  v_add_u32 v165, 4096, v165
  global_load_dwordx4 v[152:155], v165, s[46:47] sc1
  v_mfma_f32_32x32x16_bf16 v[96:111], v[148:151], v[136:139], v[96:111]
  s_waitcnt lgkmcnt(0)
  v_mfma_f32_32x32x16_bf16 v[16:31], v[120:123], v[112:115], v[16:31]
  ds_read_b128 v[132:135], v161 offset:0
  ds_read_b128 v[136:139], v161 offset:4096
  ds_read_b64_tr_b16 v[140:141], v164 offset:3072
  v_mfma_f32_32x32x16_bf16 v[64:79], v[120:123], v[116:119], v[64:79]
  ds_read_b64_tr_b16 v[142:143], v164 offset:3840
  ds_read_b64_tr_b16 v[144:145], v164 offset:3104
  ds_read_b64_tr_b16 v[146:147], v164 offset:3872
  v_mfma_f32_32x32x16_bf16 v[32:47], v[124:127], v[112:115], v[32:47]
  ds_read_b64_tr_b16 v[148:149], v164 offset:3136
  ds_read_b64_tr_b16 v[150:151], v164 offset:3904
  v_mfma_f32_32x32x16_bf16 v[80:95], v[124:127], v[116:119], v[80:95]
  v_mfma_f32_32x32x16_bf16 v[48:63], v[128:131], v[112:115], v[48:63]
  v_mfma_f32_32x32x16_bf16 v[96:111], v[128:131], v[116:119], v[96:111]
  s_waitcnt lgkmcnt(0)
  v_mfma_f32_32x32x16_bf16 v[16:31], v[140:143], v[132:135], v[16:31]
  ds_read_b128 v[112:115], v162 offset:0
  ds_read_b128 v[116:119], v162 offset:4096
  ds_read_b64_tr_b16 v[120:121], v164 offset:6144
  v_mfma_f32_32x32x16_bf16 v[64:79], v[140:143], v[136:139], v[64:79]
  ds_read_b64_tr_b16 v[122:123], v164 offset:6912
  ds_read_b64_tr_b16 v[124:125], v164 offset:6176
  ds_read_b64_tr_b16 v[126:127], v164 offset:6944
  v_mfma_f32_32x32x16_bf16 v[32:47], v[144:147], v[132:135], v[32:47]
  ds_read_b64_tr_b16 v[128:129], v164 offset:6208
  ds_read_b64_tr_b16 v[130:131], v164 offset:6976
  v_mfma_f32_32x32x16_bf16 v[80:95], v[144:147], v[136:139], v[80:95]
  v_mfma_f32_32x32x16_bf16 v[48:63], v[148:151], v[132:135], v[48:63]
  v_mfma_f32_32x32x16_bf16 v[96:111], v[148:151], v[136:139], v[96:111]
  s_waitcnt lgkmcnt(0)
  v_mfma_f32_32x32x16_bf16 v[16:31], v[120:123], v[112:115], v[16:31]
  ds_read_b128 v[132:135], v163 offset:0
  ds_read_b128 v[136:139], v163 offset:4096
  ds_read_b64_tr_b16 v[140:141], v164 offset:9216
  v_mfma_f32_32x32x16_bf16 v[64:79], v[120:123], v[116:119], v[64:79]
  ds_read_b64_tr_b16 v[142:143], v164 offset:9984
  ds_read_b64_tr_b16 v[144:145], v164 offset:9248
  ds_read_b64_tr_b16 v[146:147], v164 offset:10016
  v_mfma_f32_32x32x16_bf16 v[32:47], v[124:127], v[112:115], v[32:47]
  ds_read_b64_tr_b16 v[148:149], v164 offset:9280
  ds_read_b64_tr_b16 v[150:151], v164 offset:10048
  v_mfma_f32_32x32x16_bf16 v[80:95], v[124:127], v[116:119], v[80:95]
  v_mfma_f32_32x32x16_bf16 v[48:63], v[128:131], v[112:115], v[48:63]
  v_mfma_f32_32x32x16_bf16 v[96:111], v[128:131], v[116:119], v[96:111]
  s_waitcnt lgkmcnt(0)
  v_mfma_f32_32x32x16_bf16 v[16:31], v[140:143], v[132:135], v[16:31]
  v_add_u32 v160, 41216, v160
  v_add_u32 v161, 41216, v161
  v_add_u32 v162, 41216, v162
  v_add_u32 v163, 41216, v163
  v_add_u32 v164, 41216, v164
  v_mfma_f32_32x32x16_bf16 v[64:79], v[140:143], v[136:139], v[64:79]
  s_barrier
  ds_read_b128 v[112:115], v160 offset:0
  ds_read_b128 v[116:119], v160 offset:4096
  ds_read_b64_tr_b16 v[120:121], v164 offset:0
  v_mfma_f32_32x32x16_bf16 v[32:47], v[144:147], v[132:135], v[32:47]
  ds_read_b64_tr_b16 v[122:123], v164 offset:768
  ds_read_b64_tr_b16 v[124:125], v164 offset:32
  ds_read_b64_tr_b16 v[126:127], v164 offset:800
  v_mfma_f32_32x32x16_bf16 v[80:95], v[144:147], v[136:139], v[80:95]
  ds_read_b64_tr_b16 v[128:129], v164 offset:64
  ds_read_b64_tr_b16 v[130:131], v164 offset:832
  v_mfma_f32_32x32x16_bf16 v[48:63], v[148:151], v[132:135], v[48:63]
  s_waitcnt vmcnt(0)
  s_mov_b32 s13, 0
L_poll_2:
  v_cmp_ne_u32 vcc, s14, v152
  v_cmp_ne_u32 s[74:75], s14, v153
  s_nop 0
  s_or_b64 vcc, vcc, s[74:75]
  v_cmp_ne_u32 s[74:75], s14, v154
  s_nop 0
  s_or_b64 vcc, vcc, s[74:75]
  v_cmp_ne_u32 s[74:75], s14, v155
  s_nop 0
  s_or_b64 vcc, vcc, s[74:75]
  s_nop 1
  s_cmp_eq_u64 vcc, 0
  s_cbranch_scc1 L_pollok_3
  s_add_u32 s13, s13, 1
  s_cmp_gt_u32 s13, 131072
  s_cbranch_scc1 L_pollok_3
  s_sleep 8
  global_load_dwordx4 v[152:155], v165, s[46:47] sc1
  s_waitcnt vmcnt(0)
  s_branch L_poll_2
L_pollok_3:
  s_or_b32 s10, s2, s3
  s_cmp_lg_u32 s10, 0
  s_cbranch_scc1 L_nobump_4
  s_add_u32 s10, s34, 1
  v_mov_b32 v6, 0
  v_mov_b32 v7, s10
  s_mov_b64 s[70:71], exec
  s_mov_b64 exec, 1
  global_store_dword v6, v7, s[46:47] sc1
  s_mov_b64 exec, s[70:71]
L_nobump_4:
  s_lshl_b32 s10, s4, 7
  s_lshl_b32 s11, s6, 6
  s_add_u32 s10, s10, s11
  s_lshl_b32 s10, s10, 3
  s_add_u32 s10, s10, 65536
  v_and_b32 v6, 31, v1
  v_lshl_add_u32 v7, v6, 3, s10
  global_load_dwordx2 v[2:3], v7, s[46:47] sc1
  global_load_dwordx2 v[4:5], v7, s[46:47] offset:256 sc1
  s_mul_i32 s10, s5, 6
  s_mul_i32 s11, s7, 3
  s_add_u32 s10, s10, s11
  s_lshl_b32 s10, s10, 10
  s_add_u32 s10, s10, 131072
  v_lshl_add_u32 v7, v6, 5, s10
  v_lshrrev_b32 v8, 5, v1
  v_lshl_add_u32 v7, v8, 4, v7
  global_load_dwordx4 v[152:155], v7, s[46:47] offset:0 sc1
  global_load_dwordx4 v[156:159], v7, s[46:47] offset:1024 sc1
  global_load_dwordx4 v[168:171], v7, s[46:47] offset:2048 sc1
  v_mfma_f32_32x32x16_bf16 v[96:111], v[148:151], v[136:139], v[96:111]
  s_waitcnt lgkmcnt(0)
  v_mfma_f32_32x32x16_bf16 v[16:31], v[120:123], v[112:115], v[16:31]
  ds_read_b128 v[132:135], v161 offset:0
  ds_read_b128 v[136:139], v161 offset:4096
  ds_read_b64_tr_b16 v[140:141], v164 offset:3072
  v_mfma_f32_32x32x16_bf16 v[64:79], v[120:123], v[116:119], v[64:79]
  ds_read_b64_tr_b16 v[142:143], v164 offset:3840
  ds_read_b64_tr_b16 v[144:145], v164 offset:3104
  ds_read_b64_tr_b16 v[146:147], v164 offset:3872
  v_mfma_f32_32x32x16_bf16 v[32:47], v[124:127], v[112:115], v[32:47]
  ds_read_b64_tr_b16 v[148:149], v164 offset:3136
  ds_read_b64_tr_b16 v[150:151], v164 offset:3904
  v_mfma_f32_32x32x16_bf16 v[80:95], v[124:127], v[116:119], v[80:95]
  v_mfma_f32_32x32x16_bf16 v[48:63], v[128:131], v[112:115], v[48:63]
  v_mfma_f32_32x32x16_bf16 v[96:111], v[128:131], v[116:119], v[96:111]
  s_waitcnt lgkmcnt(0)
  v_mfma_f32_32x32x16_bf16 v[16:31], v[140:143], v[132:135], v[16:31]
  ds_read_b128 v[112:115], v162 offset:0
  ds_read_b128 v[116:119], v162 offset:4096
  ds_read_b64_tr_b16 v[120:121], v164 offset:6144
  v_mfma_f32_32x32x16_bf16 v[64:79], v[140:143], v[136:139], v[64:79]
  ds_read_b64_tr_b16 v[122:123], v164 offset:6912
  ds_read_b64_tr_b16 v[124:125], v164 offset:6176
  ds_read_b64_tr_b16 v[126:127], v164 offset:6944
  v_mfma_f32_32x32x16_bf16 v[32:47], v[144:147], v[132:135], v[32:47]
  ds_read_b64_tr_b16 v[128:129], v164 offset:6208
  ds_read_b64_tr_b16 v[130:131], v164 offset:6976
  v_mfma_f32_32x32x16_bf16 v[80:95], v[144:147], v[136:139], v[80:95]
  v_mfma_f32_32x32x16_bf16 v[48:63], v[148:151], v[132:135], v[48:63]
  v_mfma_f32_32x32x16_bf16 v[96:111], v[148:151], v[136:139], v[96:111]
  s_waitcnt lgkmcnt(0)
  v_mfma_f32_32x32x16_bf16 v[16:31], v[120:123], v[112:115], v[16:31]
  ds_read_b128 v[132:135], v163 offset:0
  ds_read_b128 v[136:139], v163 offset:4096
  ds_read_b64_tr_b16 v[140:141], v164 offset:9216
  v_mfma_f32_32x32x16_bf16 v[64:79], v[120:123], v[116:119], v[64:79]
  ds_read_b64_tr_b16 v[142:143], v164 offset:9984
  ds_read_b64_tr_b16 v[144:145], v164 offset:9248
  ds_read_b64_tr_b16 v[146:147], v164 offset:10016
  v_mfma_f32_32x32x16_bf16 v[32:47], v[124:127], v[112:115], v[32:47]
  ds_read_b64_tr_b16 v[148:149], v164 offset:9280
  ds_read_b64_tr_b16 v[150:151], v164 offset:10048
  s_waitcnt vmcnt(0)
  v_add_f32 v152, v152, v154
  v_add_f32 v153, v153, v155
  v_add_f32 v156, v156, v158
  v_add_f32 v157, v157, v159
  v_add_f32 v168, v168, v170
  v_add_f32 v169, v169, v171
  v_add_f32 v152, v152, v153
  v_add_f32 v156, v156, v157
  v_add_f32 v168, v168, v169
  v_mov_b32 v153, v152
  v_mov_b32 v157, v156
  v_mov_b32 v169, v168
  v_cmp_gt_u32 vcc, 32, v1
  v_mfma_f32_32x32x16_bf16 v[80:95], v[124:127], v[116:119], v[80:95]
  v_nop
  v_permlane32_swap_b32 v152, v153
  v_permlane32_swap_b32 v156, v157
  v_permlane32_swap_b32 v168, v169
  v_add_f32 v152, v152, v153
  v_add_f32 v156, v156, v157
  v_add_f32 v168, v168, v169
  v_cvt_pk_bf16_f32 v153, v152, v152
  v_cvt_pk_bf16_f32 v157, v156, v156
  v_cvt_pk_bf16_f32 v169, v168, v168
  v_lshlrev_b32 v154, 16, v153
  v_lshlrev_b32 v158, 16, v157
  v_lshlrev_b32 v170, 16, v169
  v_mfma_f32_32x32x16_bf16 v[48:63], v[128:131], v[112:115], v[48:63]
  v_sub_f32 v154, v152, v154
  v_sub_f32 v158, v156, v158
  v_sub_f32 v170, v168, v170
  v_cvt_pk_bf16_f32 v152, v152, v154
  v_cvt_pk_bf16_f32 v156, v156, v158
  v_cvt_pk_bf16_f32 v168, v168, v170
  v_cndmask_b32 v152, 0, v152, vcc
  v_mov_b32 v153, 0
  v_mov_b32 v154, 0
  v_mov_b32 v155, 0
  v_cndmask_b32 v156, 0, v156, vcc
  v_mov_b32 v157, 0
  v_mov_b32 v158, 0
  v_mfma_f32_32x32x16_bf16 v[96:111], v[128:131], v[116:119], v[96:111]
  v_mov_b32 v159, 0
  v_cndmask_b32 v168, 0, v168, vcc
  v_mov_b32 v169, 0
  v_mov_b32 v170, 0
  v_mov_b32 v171, 0
  v_cndmask_b32 v8, 0, v3, vcc
  v_mov_b32 v9, 0
  v_mov_b32 v10, 0
  v_mov_b32 v11, 0
  v_cndmask_b32 v12, 0, v5, vcc
  v_mov_b32 v13, 0
  v_mov_b32 v14, 0
  v_mov_b32 v15, 0
  s_waitcnt lgkmcnt(0)
  v_mfma_f32_32x32x16_bf16 v[16:31], v[140:143], v[132:135], v[16:31]
  s_barrier
  v_mfma_f32_32x32x16_bf16 v[64:79], v[140:143], v[136:139], v[64:79]
  v_mfma_f32_32x32x16_bf16 v[32:47], v[144:147], v[132:135], v[32:47]
  v_mfma_f32_32x32x16_bf16 v[80:95], v[144:147], v[136:139], v[80:95]
  v_mfma_f32_32x32x16_bf16 v[48:63], v[148:151], v[132:135], v[48:63]
  v_mfma_f32_32x32x16_bf16 v[96:111], v[148:151], v[136:139], v[96:111]
  s_nop 1
  v_mfma_f32_32x32x16_bf16 v[16:31], v[152:155], v[8:11], v[16:31]
  v_mfma_f32_32x32x16_bf16 v[64:79], v[152:155], v[12:15], v[64:79]
  v_mfma_f32_32x32x16_bf16 v[32:47], v[156:159], v[8:11], v[32:47]
  v_mfma_f32_32x32x16_bf16 v[80:95], v[156:159], v[12:15], v[80:95]
  v_mfma_f32_32x32x16_bf16 v[48:63], v[168:171], v[8:11], v[48:63]
  v_mfma_f32_32x32x16_bf16 v[96:111], v[168:171], v[12:15], v[96:111]
  v_mul_f32 v162, v2, v2
  v_mul_f32 v160, 0xc0135761, v2
  v_mul_f32 v161, 0xbdd2d3e8, v2
  v_mul_f32 v161, v161, v162
  v_rcp_f32 v162, v162
  v_mul_f32 v166, v4, v4
  v_mul_f32 v164, 0xc0135761, v4
  v_mul_f32 v165, 0xbdd2d3e8, v4
  v_mul_f32 v165, v165, v166
  v_rcp_f32 v166, v166
  s_lshl_b32 s10, s4, 2
  s_lshl_b32 s11, s6, 1
  s_add_u32 s10, s10, s11
  s_mul_i32 s10, s10, 86
  s_lshl_b32 s11, s8, 1
  s_add_u32 s10, s10, s11
  s_mul_i32 s11, s7, 3
  s_add_u32 s10, s10, s11
  s_lshl_b32 s10, s10, 10
  s_add_u32 s10, s10, 8388608
  v_lshl_add_u32 v168, v1, 4, s10
  v_add_u32 v169, 88064, v168
  s_sub_u32 s12, s72, s11
  s_lshl_b32 s10, s2, 12
  s_add_u32 s10, s10, 15728640
  v_lshl_add_u32 v170, v1, 4, s10
  s_cmp_gt_u32 s12, 1
  s_cselect_b64 s[74:75], -1, 0
  v_cndmask_b32 v171, v170, v169, s[74:75]
  v_cndmask_b32 v170, v170, v168, s[74:75]
  v_pk_mul_f32 v[112:113], v[16:17], v[16:17]
  v_pk_mul_f32 v[114:115], v[18:19], v[18:19]
  v_pk_mul_f32 v[116:117], v[20:21], v[20:21]
  v_pk_mul_f32 v[118:119], v[22:23], v[22:23]
  v_pk_fma_f32 v[112:113], v[112:113], v[160:161], v[160:161] op_sel:[0,1,0] op_sel_hi:[1,1,0]
  v_pk_fma_f32 v[114:115], v[114:115], v[160:161], v[160:161] op_sel:[0,1,0] op_sel_hi:[1,1,0]
  v_pk_fma_f32 v[116:117], v[116:117], v[160:161], v[160:161] op_sel:[0,1,0] op_sel_hi:[1,1,0]
  v_pk_fma_f32 v[118:119], v[118:119], v[160:161], v[160:161] op_sel:[0,1,0] op_sel_hi:[1,1,0]
  v_pk_mul_f32 v[112:113], v[112:113], v[16:17]
  v_pk_mul_f32 v[114:115], v[114:115], v[18:19]
  v_pk_mul_f32 v[116:117], v[116:117], v[20:21]
  v_pk_mul_f32 v[118:119], v[118:119], v[22:23]
  v_exp_f32 v112, v112
  v_exp_f32 v113, v113
  v_exp_f32 v114, v114
  v_exp_f32 v115, v115
  v_exp_f32 v116, v116
  v_exp_f32 v117, v117
  v_exp_f32 v118, v118
  v_exp_f32 v119, v119
  v_pk_mul_f32 v[120:121], v[16:17], v[24:25]
  v_pk_mul_f32 v[122:123], v[18:19], v[26:27]
  v_pk_mul_f32 v[124:125], v[20:21], v[28:29]
  v_pk_mul_f32 v[126:127], v[22:23], v[30:31]
  v_pk_fma_f32 v[112:113], v[112:113], v[162:163], v[162:163] op_sel_hi:[1,0,0]
  v_pk_fma_f32 v[114:115], v[114:115], v[162:163], v[162:163] op_sel_hi:[1,0,0]
  v_pk_fma_f32 v[116:117], v[116:117], v[162:163], v[162:163] op_sel_hi:[1,0,0]
  v_pk_fma_f32 v[118:119], v[118:119], v[162:163], v[162:163] op_sel_hi:[1,0,0]
  v_rcp_f32 v112, v112
  v_rcp_f32 v113, v113
  v_rcp_f32 v114, v114
  v_rcp_f32 v115, v115
  v_rcp_f32 v116, v116
  v_rcp_f32 v117, v117
  v_rcp_f32 v118, v118
  v_rcp_f32 v119, v119
  s_nop 0
  v_pk_mul_f32 v[120:121], v[120:121], v[112:113]
  v_pk_mul_f32 v[122:123], v[122:123], v[114:115]
  v_pk_mul_f32 v[124:125], v[124:125], v[116:117]
  v_pk_mul_f32 v[126:127], v[126:127], v[118:119]
  v_cvt_pk_bf16_f32 v128, v120, v121
  v_cvt_pk_bf16_f32 v129, v122, v123
  v_cvt_pk_bf16_f32 v130, v124, v125
  v_cvt_pk_bf16_f32 v131, v126, v127
  global_store_dwordx4 v168, v[128:131], s[46:47] offset:0 sc1
  v_pk_mul_f32 v[112:113], v[64:65], v[64:65]
  v_pk_mul_f32 v[114:115], v[66:67], v[66:67]
  v_pk_mul_f32 v[116:117], v[68:69], v[68:69]
  v_pk_mul_f32 v[118:119], v[70:71], v[70:71]
  v_pk_fma_f32 v[112:113], v[112:113], v[164:165], v[164:165] op_sel:[0,1,0] op_sel_hi:[1,1,0]
  v_pk_fma_f32 v[114:115], v[114:115], v[164:165], v[164:165] op_sel:[0,1,0] op_sel_hi:[1,1,0]
  v_pk_fma_f32 v[116:117], v[116:117], v[164:165], v[164:165] op_sel:[0,1,0] op_sel_hi:[1,1,0]
  v_pk_fma_f32 v[118:119], v[118:119], v[164:165], v[164:165] op_sel:[0,1,0] op_sel_hi:[1,1,0]
  v_pk_mul_f32 v[112:113], v[112:113], v[64:65]
  v_pk_mul_f32 v[114:115], v[114:115], v[66:67]
  v_pk_mul_f32 v[116:117], v[116:117], v[68:69]
  v_pk_mul_f32 v[118:119], v[118:119], v[70:71]
  v_exp_f32 v112, v112
  v_exp_f32 v113, v113
  v_exp_f32 v114, v114
  v_exp_f32 v115, v115
  v_exp_f32 v116, v116
  v_exp_f32 v117, v117
  v_exp_f32 v118, v118
  v_exp_f32 v119, v119
  v_pk_mul_f32 v[120:121], v[64:65], v[72:73]
  v_pk_mul_f32 v[122:123], v[66:67], v[74:75]
  v_pk_mul_f32 v[124:125], v[68:69], v[76:77]
  v_pk_mul_f32 v[126:127], v[70:71], v[78:79]
  v_pk_fma_f32 v[112:113], v[112:113], v[166:167], v[166:167] op_sel_hi:[1,0,0]
  v_pk_fma_f32 v[114:115], v[114:115], v[166:167], v[166:167] op_sel_hi:[1,0,0]
  v_pk_fma_f32 v[116:117], v[116:117], v[166:167], v[166:167] op_sel_hi:[1,0,0]
  v_pk_fma_f32 v[118:119], v[118:119], v[166:167], v[166:167] op_sel_hi:[1,0,0]
  v_rcp_f32 v112, v112
  v_rcp_f32 v113, v113
  v_rcp_f32 v114, v114
  v_rcp_f32 v115, v115
  v_rcp_f32 v116, v116
  v_rcp_f32 v117, v117
  v_rcp_f32 v118, v118
  v_rcp_f32 v119, v119
  s_nop 0
  v_pk_mul_f32 v[120:121], v[120:121], v[112:113]
  v_pk_mul_f32 v[122:123], v[122:123], v[114:115]
  v_pk_mul_f32 v[124:125], v[124:125], v[116:117]
  v_pk_mul_f32 v[126:127], v[126:127], v[118:119]
  v_cvt_pk_bf16_f32 v132, v120, v121
  v_cvt_pk_bf16_f32 v133, v122, v123
  v_cvt_pk_bf16_f32 v134, v124, v125
  v_cvt_pk_bf16_f32 v135, v126, v127
  global_store_dwordx4 v169, v[132:135], s[46:47] offset:0 sc1
  v_pk_mul_f32 v[112:113], v[32:33], v[32:33]
  v_pk_mul_f32 v[114:115], v[34:35], v[34:35]
  v_pk_mul_f32 v[116:117], v[36:37], v[36:37]
  v_pk_mul_f32 v[118:119], v[38:39], v[38:39]
  v_pk_fma_f32 v[112:113], v[112:113], v[160:161], v[160:161] op_sel:[0,1,0] op_sel_hi:[1,1,0]
  v_pk_fma_f32 v[114:115], v[114:115], v[160:161], v[160:161] op_sel:[0,1,0] op_sel_hi:[1,1,0]
  v_pk_fma_f32 v[116:117], v[116:117], v[160:161], v[160:161] op_sel:[0,1,0] op_sel_hi:[1,1,0]
  v_pk_fma_f32 v[118:119], v[118:119], v[160:161], v[160:161] op_sel:[0,1,0] op_sel_hi:[1,1,0]
  v_pk_mul_f32 v[112:113], v[112:113], v[32:33]
  v_pk_mul_f32 v[114:115], v[114:115], v[34:35]
  v_pk_mul_f32 v[116:117], v[116:117], v[36:37]
  v_pk_mul_f32 v[118:119], v[118:119], v[38:39]
  v_exp_f32 v112, v112
  v_exp_f32 v113, v113
  v_exp_f32 v114, v114
  v_exp_f32 v115, v115
  v_exp_f32 v116, v116
  v_exp_f32 v117, v117
  v_exp_f32 v118, v118
  v_exp_f32 v119, v119
  v_pk_mul_f32 v[120:121], v[32:33], v[40:41]
  v_pk_mul_f32 v[122:123], v[34:35], v[42:43]
  v_pk_mul_f32 v[124:125], v[36:37], v[44:45]
  v_pk_mul_f32 v[126:127], v[38:39], v[46:47]
  v_pk_fma_f32 v[112:113], v[112:113], v[162:163], v[162:163] op_sel_hi:[1,0,0]
  v_pk_fma_f32 v[114:115], v[114:115], v[162:163], v[162:163] op_sel_hi:[1,0,0]
  v_pk_fma_f32 v[116:117], v[116:117], v[162:163], v[162:163] op_sel_hi:[1,0,0]
  v_pk_fma_f32 v[118:119], v[118:119], v[162:163], v[162:163] op_sel_hi:[1,0,0]
  v_rcp_f32 v112, v112
  v_rcp_f32 v113, v113
  v_rcp_f32 v114, v114
  v_rcp_f32 v115, v115
  v_rcp_f32 v116, v116
  v_rcp_f32 v117, v117
  v_rcp_f32 v118, v118
  v_rcp_f32 v119, v119
  s_nop 0
  v_pk_mul_f32 v[120:121], v[120:121], v[112:113]
  v_pk_mul_f32 v[122:123], v[122:123], v[114:115]
  v_pk_mul_f32 v[124:125], v[124:125], v[116:117]
  v_pk_mul_f32 v[126:127], v[126:127], v[118:119]
  v_cvt_pk_bf16_f32 v128, v120, v121
  v_cvt_pk_bf16_f32 v129, v122, v123
  v_cvt_pk_bf16_f32 v130, v124, v125
  v_cvt_pk_bf16_f32 v131, v126, v127
  global_store_dwordx4 v170, v[128:131], s[46:47] offset:1024 sc1
  v_pk_mul_f32 v[112:113], v[80:81], v[80:81]
  v_pk_mul_f32 v[114:115], v[82:83], v[82:83]
  v_pk_mul_f32 v[116:117], v[84:85], v[84:85]
  v_pk_mul_f32 v[118:119], v[86:87], v[86:87]
  v_pk_fma_f32 v[112:113], v[112:113], v[164:165], v[164:165] op_sel:[0,1,0] op_sel_hi:[1,1,0]
  v_pk_fma_f32 v[114:115], v[114:115], v[164:165], v[164:165] op_sel:[0,1,0] op_sel_hi:[1,1,0]
  v_pk_fma_f32 v[116:117], v[116:117], v[164:165], v[164:165] op_sel:[0,1,0] op_sel_hi:[1,1,0]
  v_pk_fma_f32 v[118:119], v[118:119], v[164:165], v[164:165] op_sel:[0,1,0] op_sel_hi:[1,1,0]
  v_pk_mul_f32 v[112:113], v[112:113], v[80:81]
  v_pk_mul_f32 v[114:115], v[114:115], v[82:83]
  v_pk_mul_f32 v[116:117], v[116:117], v[84:85]
  v_pk_mul_f32 v[118:119], v[118:119], v[86:87]
  v_exp_f32 v112, v112
  v_exp_f32 v113, v113
  v_exp_f32 v114, v114
  v_exp_f32 v115, v115
  v_exp_f32 v116, v116
  v_exp_f32 v117, v117
  v_exp_f32 v118, v118
  v_exp_f32 v119, v119
  v_pk_mul_f32 v[120:121], v[80:81], v[88:89]
  v_pk_mul_f32 v[122:123], v[82:83], v[90:91]
  v_pk_mul_f32 v[124:125], v[84:85], v[92:93]
  v_pk_mul_f32 v[126:127], v[86:87], v[94:95]
  v_pk_fma_f32 v[112:113], v[112:113], v[166:167], v[166:167] op_sel_hi:[1,0,0]
  v_pk_fma_f32 v[114:115], v[114:115], v[166:167], v[166:167] op_sel_hi:[1,0,0]
  v_pk_fma_f32 v[116:117], v[116:117], v[166:167], v[166:167] op_sel_hi:[1,0,0]
  v_pk_fma_f32 v[118:119], v[118:119], v[166:167], v[166:167] op_sel_hi:[1,0,0]
  v_rcp_f32 v112, v112
  v_rcp_f32 v113, v113
  v_rcp_f32 v114, v114
  v_rcp_f32 v115, v115
  v_rcp_f32 v116, v116
  v_rcp_f32 v117, v117
  v_rcp_f32 v118, v118
  v_rcp_f32 v119, v119
  s_nop 0
  v_pk_mul_f32 v[120:121], v[120:121], v[112:113]
  v_pk_mul_f32 v[122:123], v[122:123], v[114:115]
  v_pk_mul_f32 v[124:125], v[124:125], v[116:117]
  v_pk_mul_f32 v[126:127], v[126:127], v[118:119]
  v_cvt_pk_bf16_f32 v132, v120, v121
  v_cvt_pk_bf16_f32 v133, v122, v123
  v_cvt_pk_bf16_f32 v134, v124, v125
  v_cvt_pk_bf16_f32 v135, v126, v127
  global_store_dwordx4 v171, v[132:135], s[46:47] offset:1024 sc1
  v_pk_mul_f32 v[112:113], v[48:49], v[48:49]
  v_pk_mul_f32 v[114:115], v[50:51], v[50:51]
  v_pk_mul_f32 v[116:117], v[52:53], v[52:53]
  v_pk_mul_f32 v[118:119], v[54:55], v[54:55]
  v_pk_fma_f32 v[112:113], v[112:113], v[160:161], v[160:161] op_sel:[0,1,0] op_sel_hi:[1,1,0]
  v_pk_fma_f32 v[114:115], v[114:115], v[160:161], v[160:161] op_sel:[0,1,0] op_sel_hi:[1,1,0]
  v_pk_fma_f32 v[116:117], v[116:117], v[160:161], v[160:161] op_sel:[0,1,0] op_sel_hi:[1,1,0]
  v_pk_fma_f32 v[118:119], v[118:119], v[160:161], v[160:161] op_sel:[0,1,0] op_sel_hi:[1,1,0]
  v_pk_mul_f32 v[112:113], v[112:113], v[48:49]
  v_pk_mul_f32 v[114:115], v[114:115], v[50:51]
  v_pk_mul_f32 v[116:117], v[116:117], v[52:53]
  v_pk_mul_f32 v[118:119], v[118:119], v[54:55]
  v_exp_f32 v112, v112
  v_exp_f32 v113, v113
  v_exp_f32 v114, v114
  v_exp_f32 v115, v115
  v_exp_f32 v116, v116
  v_exp_f32 v117, v117
  v_exp_f32 v118, v118
  v_exp_f32 v119, v119
  v_pk_mul_f32 v[120:121], v[48:49], v[56:57]
  v_pk_mul_f32 v[122:123], v[50:51], v[58:59]
  v_pk_mul_f32 v[124:125], v[52:53], v[60:61]
  v_pk_mul_f32 v[126:127], v[54:55], v[62:63]
  v_pk_fma_f32 v[112:113], v[112:113], v[162:163], v[162:163] op_sel_hi:[1,0,0]
  v_pk_fma_f32 v[114:115], v[114:115], v[162:163], v[162:163] op_sel_hi:[1,0,0]
  v_pk_fma_f32 v[116:117], v[116:117], v[162:163], v[162:163] op_sel_hi:[1,0,0]
  v_pk_fma_f32 v[118:119], v[118:119], v[162:163], v[162:163] op_sel_hi:[1,0,0]
  v_rcp_f32 v112, v112
  v_rcp_f32 v113, v113
  v_rcp_f32 v114, v114
  v_rcp_f32 v115, v115
  v_rcp_f32 v116, v116
  v_rcp_f32 v117, v117
  v_rcp_f32 v118, v118
  v_rcp_f32 v119, v119
  s_nop 0
  v_pk_mul_f32 v[120:121], v[120:121], v[112:113]
  v_pk_mul_f32 v[122:123], v[122:123], v[114:115]
  v_pk_mul_f32 v[124:125], v[124:125], v[116:117]
  v_pk_mul_f32 v[126:127], v[126:127], v[118:119]
  v_cvt_pk_bf16_f32 v128, v120, v121
  v_cvt_pk_bf16_f32 v129, v122, v123
  v_cvt_pk_bf16_f32 v130, v124, v125
  v_cvt_pk_bf16_f32 v131, v126, v127
  global_store_dwordx4 v170, v[128:131], s[46:47] offset:2048 sc1
  v_pk_mul_f32 v[112:113], v[96:97], v[96:97]
  v_pk_mul_f32 v[114:115], v[98:99], v[98:99]
  v_pk_mul_f32 v[116:117], v[100:101], v[100:101]
  v_pk_mul_f32 v[118:119], v[102:103], v[102:103]
  v_pk_fma_f32 v[112:113], v[112:113], v[164:165], v[164:165] op_sel:[0,1,0] op_sel_hi:[1,1,0]
  v_pk_fma_f32 v[114:115], v[114:115], v[164:165], v[164:165] op_sel:[0,1,0] op_sel_hi:[1,1,0]
  v_pk_fma_f32 v[116:117], v[116:117], v[164:165], v[164:165] op_sel:[0,1,0] op_sel_hi:[1,1,0]
  v_pk_fma_f32 v[118:119], v[118:119], v[164:165], v[164:165] op_sel:[0,1,0] op_sel_hi:[1,1,0]
  v_pk_mul_f32 v[112:113], v[112:113], v[96:97]
  v_pk_mul_f32 v[114:115], v[114:115], v[98:99]
  v_pk_mul_f32 v[116:117], v[116:117], v[100:101]
  v_pk_mul_f32 v[118:119], v[118:119], v[102:103]
  v_exp_f32 v112, v112
  v_exp_f32 v113, v113
  v_exp_f32 v114, v114
  v_exp_f32 v115, v115
  v_exp_f32 v116, v116
  v_exp_f32 v117, v117
  v_exp_f32 v118, v118
  v_exp_f32 v119, v119
  v_pk_mul_f32 v[120:121], v[96:97], v[104:105]
  v_pk_mul_f32 v[122:123], v[98:99], v[106:107]
  v_pk_mul_f32 v[124:125], v[100:101], v[108:109]
  v_pk_mul_f32 v[126:127], v[102:103], v[110:111]
  v_pk_fma_f32 v[112:113], v[112:113], v[166:167], v[166:167] op_sel_hi:[1,0,0]
  v_pk_fma_f32 v[114:115], v[114:115], v[166:167], v[166:167] op_sel_hi:[1,0,0]
  v_pk_fma_f32 v[116:117], v[116:117], v[166:167], v[166:167] op_sel_hi:[1,0,0]
  v_pk_fma_f32 v[118:119], v[118:119], v[166:167], v[166:167] op_sel_hi:[1,0,0]
  v_rcp_f32 v112, v112
  v_rcp_f32 v113, v113
  v_rcp_f32 v114, v114
  v_rcp_f32 v115, v115
  v_rcp_f32 v116, v116
  v_rcp_f32 v117, v117
  v_rcp_f32 v118, v118
  v_rcp_f32 v119, v119
  s_nop 0
  v_pk_mul_f32 v[120:121], v[120:121], v[112:113]
  v_pk_mul_f32 v[122:123], v[122:123], v[114:115]
  v_pk_mul_f32 v[124:125], v[124:125], v[116:117]
  v_pk_mul_f32 v[126:127], v[126:127], v[118:119]
  v_cvt_pk_bf16_f32 v132, v120, v121
  v_cvt_pk_bf16_f32 v133, v122, v123
  v_cvt_pk_bf16_f32 v134, v124, v125
  v_cvt_pk_bf16_f32 v135, v126, v127
  global_store_dwordx4 v171, v[132:135], s[46:47] offset:2048 sc1
  s_lshl_b32 s10, s4, 2
  s_lshl_b32 s11, s79, 1
  s_add_u32 s10, s10, s11
  s_mul_i32 s10, s10, 86
  s_mul_i32 s11, s3, 22
  s_add_u32 s10, s10, s11
  s_lshl_b32 s10, s10, 10
  s_add_u32 s10, s10, 8388608
  v_lshl_add_u32 v160, v1, 4, s10
  v_add_u32 v161, 88064, v160
  s_movk_i32 s66, 4096
  s_movk_i32 s67, 5120
  s_cmp_eq_u32 s3, 3
  s_cselect_b32 s66, 3072, s66
  s_cselect_b32 s67, 3072, s67
  s_waitcnt vmcnt(0)
  s_barrier
  s_cmp_lg_u32 s3, 0
  s_cbranch_scc1 L_nofl_5
  s_lshl_b32 s10, s4, 4
  s_add_u32 s10, s10, s5
  s_lshl_b32 s10, s10, 2
  s_add_u32 s10, s10, 8192
  v_mov_b32 v6, s10
  v_mov_b32 v7, s14
  s_mov_b64 s[70:71], exec
  s_mov_b64 exec, 1
  global_store_dword v6, v7, s[46:47] sc1
  s_mov_b64 exec, s[70:71]
L_nofl_5:
  s_cmp_lg_u32 s3, 0
  s_cbranch_scc1 L_nofl_6
  s_and_b32 s10, s2, 7
  s_lshl_b32 s10, s10, 5
  s_lshr_b32 s11, s2, 3
  s_add_u32 s10, s10, s11
  s_lshl_b32 s10, s10, 2
  s_add_u32 s10, s10, 12288
  v_mov_b32 v6, s10
  v_mov_b32 v7, s14
  s_mov_b64 s[70:71], exec
  s_mov_b64 exec, 1
  global_store_dword v6, v7, s[46:47] sc1
  s_mov_b64 exec, s[70:71]
L_nofl_6:
  s_mul_i32 s10, s3, 6144
  s_add_u32 s10, s10, 0
  v_add_u32 v166, s10, v173
  v_add_u32 v167, s10, v174
  ds_read_b64_tr_b16 a[0:1], v166 offset:0
  ds_read_b64_tr_b16 a[2:3], v166 offset:1024
  ds_read_b64_tr_b16 a[4:5], v167 offset:0
  ds_read_b64_tr_b16 a[6:7], v167 offset:1024
  ds_read_b64_tr_b16 a[8:9], v166 offset:2048
  ds_read_b64_tr_b16 a[10:11], v166 offset:3072
  ds_read_b64_tr_b16 a[12:13], v167 offset:2048
  ds_read_b64_tr_b16 a[14:15], v167 offset:3072
  ds_read_b64_tr_b16 a[16:17], v166 offset:4096
  ds_read_b64_tr_b16 a[18:19], v166 offset:5120
  ds_read_b64_tr_b16 a[20:21], v167 offset:4096
  ds_read_b64_tr_b16 a[22:23], v167 offset:5120
  s_mul_i32 s10, s3, 10240
  s_add_u32 s10, s10, 41216
  v_add_u32 v166, s10, v173
  v_add_u32 v167, s10, v174
  ds_read_b64_tr_b16 a[24:25], v166 offset:0
  ds_read_b64_tr_b16 a[26:27], v166 offset:1024
  ds_read_b64_tr_b16 a[28:29], v167 offset:0
  ds_read_b64_tr_b16 a[30:31], v167 offset:1024
  ds_read_b64_tr_b16 a[32:33], v166 offset:2048
  ds_read_b64_tr_b16 a[34:35], v166 offset:3072
  ds_read_b64_tr_b16 a[36:37], v167 offset:2048
  ds_read_b64_tr_b16 a[38:39], v167 offset:3072
  ds_read_b64_tr_b16 a[40:41], v166 offset:4096
  ds_read_b64_tr_b16 a[42:43], v166 offset:5120
  ds_read_b64_tr_b16 a[44:45], v167 offset:4096
  ds_read_b64_tr_b16 a[46:47], v167 offset:5120
  ds_read_b64_tr_b16 a[48:49], v166 offset:6144
  ds_read_b64_tr_b16 a[50:51], v166 offset:7168
  ds_read_b64_tr_b16 a[52:53], v167 offset:6144
  ds_read_b64_tr_b16 a[54:55], v167 offset:7168
  ds_read_b64_tr_b16 a[56:57], v166 offset:8192
  ds_read_b64_tr_b16 a[58:59], v166 offset:9216
  ds_read_b64_tr_b16 a[60:61], v167 offset:8192
  ds_read_b64_tr_b16 a[62:63], v167 offset:9216
  s_waitcnt lgkmcnt(0)
  s_mul_i32 s15, s3, 6144
  s_add_u32 s73, s81, 131072
  s_add_u32 m0, s15, 0
  s_nop 0
  buffer_load_dwordx4 v172, s[60:63], s73 offen lds
  s_add_u32 s73, s73, 8192
  s_add_u32 m0, s15, 1024
  s_nop 0
  buffer_load_dwordx4 v172, s[60:63], s73 offen lds
  s_add_u32 s73, s73, 8192
  s_add_u32 m0, s15, 2048
  s_nop 0
  buffer_load_dwordx4 v172, s[60:63], s73 offen lds
  s_add_u32 s73, s73, 8192
  s_add_u32 m0, s15, 3072
  s_nop 0
  buffer_load_dwordx4 v172, s[60:63], s73 offen lds
  s_add_u32 s73, s73, 8192
  s_add_u32 m0, s15, 4096
  s_nop 0
  buffer_load_dwordx4 v172, s[60:63], s73 offen lds
  s_add_u32 s73, s73, 8192
  s_add_u32 m0, s15, 5120
  s_nop 0
  buffer_load_dwordx4 v172, s[60:63], s73 offen lds
  s_add_u32 s73, s73, 8192
  s_mul_i32 s15, s3, 10240
  s_add_u32 s73, s81, 180224
  s_add_u32 m0, s15, 41216
  s_nop 0
  buffer_load_dwordx4 v172, s[60:63], s73 offen lds
  s_add_u32 s73, s73, 8192
  s_add_u32 m0, s15, 42240
  s_nop 0
  buffer_load_dwordx4 v172, s[60:63], s73 offen lds
  s_add_u32 s73, s73, 8192
  s_add_u32 m0, s15, 43264
  s_nop 0
  buffer_load_dwordx4 v172, s[60:63], s73 offen lds
  s_add_u32 s73, s73, 8192
  s_add_u32 m0, s15, 44288
  s_nop 0
  buffer_load_dwordx4 v172, s[60:63], s73 offen lds
  s_add_u32 s73, s73, 8192
  s_add_u32 m0, s15, 45312
  s_nop 0
  buffer_load_dwordx4 v172, s[60:63], s73 offen lds
  s_add_u32 s73, s73, 8192
  s_add_u32 m0, s15, 46336
  s_nop 0
  buffer_load_dwordx4 v172, s[60:63], s73 offen lds
  s_add_u32 s73, s73, 8192
  s_add_u32 m0, s15, 47360
  s_nop 0
  buffer_load_dwordx4 v172, s[60:63], s73 offen lds
  s_add_u32 s73, s73, 8192
  s_add_u32 m0, s15, 48384
  s_nop 0
  buffer_load_dwordx4 v172, s[60:63], s73 offen lds
  s_add_u32 s73, s73, 8192
  s_add_u32 m0, s15, 49408
  s_nop 0
  buffer_load_dwordx4 v172, s[60:63], s73 offen lds
  s_add_u32 s73, s73, 8192
  s_add_u32 m0, s15, 50432
  s_nop 0
  buffer_load_dwordx4 v172, s[60:63], s73 offen lds
  s_add_u32 s73, s73, 8192
  s_barrier
  s_lshl_b32 s10, s4, 6
  s_add_u32 s10, s10, 8192
  v_and_b32 v8, 15, v1
  v_lshl_add_u32 v8, v8, 2, s10
  s_lshl_b32 s10, s80, 7
  s_add_u32 s10, s10, 12288
  v_and_b32 v9, 31, v1
  v_lshl_add_u32 v9, v9, 2, s10
  global_load_dword v10, v8, s[46:47] sc1
  global_load_dword v11, v9, s[46:47] sc1
  s_waitcnt vmcnt(0)
  s_mov_b32 s13, 0
L_poll_7:
  v_cmp_ne_u32 vcc, s14, v10
  v_cmp_ne_u32 s[74:75], s14, v11
  s_nop 1
  s_or_b64 vcc, vcc, s[74:75]
  s_cmp_eq_u64 vcc, 0
  s_cbranch_scc1 L_pollok_8
  s_add_u32 s13, s13, 1
  s_cmp_gt_u32 s13, 131072
  s_cbranch_scc1 L_pollok_8
  s_sleep 8
  global_load_dword v10, v8, s[46:47] sc1
  global_load_dword v11, v9, s[46:47] sc1
  s_waitcnt vmcnt(0)
  s_branch L_poll_7
L_pollok_8:
  global_load_dwordx4 v[80:83], v160, s[46:47] offset:0 sc1
  global_load_dwordx4 v[84:87], v161, s[46:47] offset:0 sc1
  global_load_dwordx4 v[88:91], v160, s[46:47] offset:1024 sc1
  global_load_dwordx4 v[92:95], v161, s[46:47] offset:1024 sc1
  global_load_dwordx4 v[96:99], v160, s[46:47] offset:2048 sc1
  global_load_dwordx4 v[100:103], v161, s[46:47] offset:2048 sc1
  global_load_dwordx4 v[104:107], v160, s[46:47] offset:3072 sc1
  global_load_dwordx4 v[108:111], v161, s[46:47] offset:3072 sc1
  s_waitcnt lgkmcnt(0)
  s_waitcnt vmcnt(6)
  v_mfma_f32_32x32x16_bf16 v[16:31], a[0:3], v[80:83], 0
  v_mfma_f32_32x32x16_bf16 v[32:47], a[0:3], v[84:87], 0
  v_add_u32 v160, 4096, v160
  v_add_u32 v161, 4096, v161
  global_load_dwordx4 v[112:115], v160, s[46:47] offset:0 sc1
  global_load_dwordx4 v[116:119], v161, s[46:47] offset:0 sc1
  v_mfma_f32_32x32x16_bf16 v[48:63], a[4:7], v[80:83], 0
  v_mfma_f32_32x32x16_bf16 v[64:79], a[4:7], v[84:87], 0
  global_load_dwordx4 v[120:123], v160, s[46:47] offset:1024 sc1
  global_load_dwordx4 v[124:127], v161, s[46:47] offset:1024 sc1
  s_waitcnt vmcnt(8)
  v_mfma_f32_32x32x16_bf16 v[16:31], a[8:11], v[88:91], v[16:31]
  v_mfma_f32_32x32x16_bf16 v[32:47], a[8:11], v[92:95], v[32:47]
  global_load_dwordx4 v[128:131], v160, s[46:47] offset:2048 sc1
  global_load_dwordx4 v[132:135], v161, s[46:47] offset:2048 sc1
  v_mfma_f32_32x32x16_bf16 v[48:63], a[12:15], v[88:91], v[48:63]
  v_mfma_f32_32x32x16_bf16 v[64:79], a[12:15], v[92:95], v[64:79]
  global_load_dwordx4 v[136:139], v160, s[46:47] offset:3072 sc1
  global_load_dwordx4 v[140:143], v161, s[46:47] offset:3072 sc1
  s_waitcnt vmcnt(10)
  v_mfma_f32_32x32x16_bf16 v[16:31], a[16:19], v[96:99], v[16:31]
  v_mfma_f32_32x32x16_bf16 v[32:47], a[16:19], v[100:103], v[32:47]
  v_add_u32 v160, 4096, v160
  v_add_u32 v161, 4096, v161
  global_load_dwordx4 v[80:83], v160, s[46:47] offset:0 sc1
  global_load_dwordx4 v[84:87], v161, s[46:47] offset:0 sc1
  v_mfma_f32_32x32x16_bf16 v[48:63], a[20:23], v[96:99], v[48:63]
  s_barrier
  v_mfma_f32_32x32x16_bf16 v[64:79], a[20:23], v[100:103], v[64:79]
  global_load_dwordx4 v[88:91], v160, s[46:47] offset:1024 sc1
  global_load_dwordx4 v[92:95], v161, s[46:47] offset:1024 sc1
  s_waitcnt vmcnt(12)
  v_mfma_f32_32x32x16_bf16 v[16:31], a[24:27], v[104:107], v[16:31]
  v_mfma_f32_32x32x16_bf16 v[32:47], a[24:27], v[108:111], v[32:47]
  global_load_dwordx4 v[96:99], v160, s[46:47] offset:2048 sc1
  global_load_dwordx4 v[100:103], v161, s[46:47] offset:2048 sc1
  v_mfma_f32_32x32x16_bf16 v[48:63], a[28:31], v[104:107], v[48:63]
  v_mfma_f32_32x32x16_bf16 v[64:79], a[28:31], v[108:111], v[64:79]
  s_waitcnt vmcnt(12)
  v_mfma_f32_32x32x16_bf16 v[16:31], a[32:35], v[112:115], v[16:31]
  v_mfma_f32_32x32x16_bf16 v[32:47], a[32:35], v[116:119], v[32:47]
  global_load_dwordx4 v[104:107], v160, s[46:47] offset:3072 sc1
  global_load_dwordx4 v[108:111], v161, s[46:47] offset:3072 sc1
  v_mfma_f32_32x32x16_bf16 v[48:63], a[36:39], v[112:115], v[48:63]
  s_barrier
  s_mul_i32 s10, s3, 4096
  s_add_u32 s10, s10, 115200
  v_add_u32 v12, s10, v173
  v_add_u32 v13, s10, v174
  ds_read_b64_tr_b16 a[64:65], v12 offset:0
  ds_read_b64_tr_b16 a[66:67], v12 offset:1024
  ds_read_b64_tr_b16 a[68:69], v13 offset:0
  ds_read_b64_tr_b16 a[70:71], v13 offset:1024
  ds_read_b64_tr_b16 a[72:73], v12 offset:2048
  ds_read_b64_tr_b16 a[74:75], v12 offset:3072
  ds_read_b64_tr_b16 a[76:77], v13 offset:2048
  ds_read_b64_tr_b16 a[78:79], v13 offset:3072
  v_mfma_f32_32x32x16_bf16 v[64:79], a[36:39], v[116:119], v[64:79]
  s_waitcnt vmcnt(12)
  v_mfma_f32_32x32x16_bf16 v[16:31], a[40:43], v[120:123], v[16:31]
  v_mfma_f32_32x32x16_bf16 v[32:47], a[40:43], v[124:127], v[32:47]
  v_add_u32 v160, 4096, v160
  v_add_u32 v161, 4096, v161
  global_load_dwordx4 v[112:115], v160, s[46:47] offset:0 sc1
  global_load_dwordx4 v[116:119], v161, s[46:47] offset:0 sc1
  v_mfma_f32_32x32x16_bf16 v[48:63], a[44:47], v[120:123], v[48:63]
  v_mfma_f32_32x32x16_bf16 v[64:79], a[44:47], v[124:127], v[64:79]
  s_waitcnt vmcnt(12)
  v_mfma_f32_32x32x16_bf16 v[16:31], a[48:51], v[128:131], v[16:31]
  v_mfma_f32_32x32x16_bf16 v[32:47], a[48:51], v[132:135], v[32:47]
  global_load_dwordx4 v[120:123], v160, s[46:47] offset:1024 sc1
  global_load_dwordx4 v[124:127], v161, s[46:47] offset:1024 sc1
  v_mfma_f32_32x32x16_bf16 v[48:63], a[52:55], v[128:131], v[48:63]
  v_mfma_f32_32x32x16_bf16 v[64:79], a[52:55], v[132:135], v[64:79]
  s_waitcnt vmcnt(12)
  v_mfma_f32_32x32x16_bf16 v[16:31], a[56:59], v[136:139], v[16:31]
  s_mul_i32 s10, s3, 6144
  s_add_u32 s10, s10, 0
  v_add_u32 v166, s10, v173
  v_add_u32 v167, s10, v174
  ds_read_b64_tr_b16 v[144:145], v166 offset:0
  ds_read_b64_tr_b16 v[146:147], v166 offset:1024
  ds_read_b64_tr_b16 v[148:149], v167 offset:0
  ds_read_b64_tr_b16 v[150:151], v167 offset:1024
  v_mfma_f32_32x32x16_bf16 v[32:47], a[56:59], v[140:143], v[32:47]
  global_load_dwordx4 v[128:131], v160, s[46:47] offset:2048 sc1
  global_load_dwordx4 v[132:135], v161, s[46:47] offset:2048 sc1
  v_mfma_f32_32x32x16_bf16 v[48:63], a[60:63], v[136:139], v[48:63]
  v_mfma_f32_32x32x16_bf16 v[64:79], a[60:63], v[140:143], v[64:79]
  s_waitcnt vmcnt(12)
  s_waitcnt lgkmcnt(0)
  v_mfma_f32_32x32x16_bf16 v[16:31], v[144:147], v[80:83], v[16:31]
  ds_read_b64_tr_b16 v[152:153], v166 offset:2048
  ds_read_b64_tr_b16 v[154:155], v166 offset:3072
  ds_read_b64_tr_b16 v[156:157], v167 offset:2048
  ds_read_b64_tr_b16 v[158:159], v167 offset:3072
  v_mfma_f32_32x32x16_bf16 v[32:47], v[144:147], v[84:87], v[32:47]
  global_load_dwordx4 v[136:139], v160, s[46:47] offset:3072 sc1
  global_load_dwordx4 v[140:143], v161, s[46:47] offset:3072 sc1
  v_mfma_f32_32x32x16_bf16 v[48:63], v[148:151], v[80:83], v[48:63]
  v_mfma_f32_32x32x16_bf16 v[64:79], v[148:151], v[84:87], v[64:79]
  s_waitcnt vmcnt(12)
  s_waitcnt lgkmcnt(0)
  v_mfma_f32_32x32x16_bf16 v[16:31], v[152:155], v[88:91], v[16:31]
  ds_read_b64_tr_b16 v[144:145], v166 offset:4096
  ds_read_b64_tr_b16 v[146:147], v166 offset:5120
  ds_read_b64_tr_b16 v[148:149], v167 offset:4096
  ds_read_b64_tr_b16 v[150:151], v167 offset:5120
  v_mfma_f32_32x32x16_bf16 v[32:47], v[152:155], v[92:95], v[32:47]
  v_add_u32 v160, 4096, v160
  v_add_u32 v161, 4096, v161
  global_load_dwordx4 v[80:83], v160, s[46:47] offset:0 sc1
  global_load_dwordx4 v[84:87], v161, s[46:47] offset:0 sc1
  v_mfma_f32_32x32x16_bf16 v[48:63], v[156:159], v[88:91], v[48:63]
  v_mfma_f32_32x32x16_bf16 v[64:79], v[156:159], v[92:95], v[64:79]
  s_waitcnt vmcnt(12)
  s_waitcnt lgkmcnt(0)
  v_mfma_f32_32x32x16_bf16 v[16:31], v[144:147], v[96:99], v[16:31]
  s_mul_i32 s10, s3, 10240
  s_add_u32 s10, s10, 41216
  v_add_u32 v166, s10, v173
  v_add_u32 v167, s10, v174
  ds_read_b64_tr_b16 v[152:153], v166 offset:0
  ds_read_b64_tr_b16 v[154:155], v166 offset:1024
  ds_read_b64_tr_b16 v[156:157], v167 offset:0
  ds_read_b64_tr_b16 v[158:159], v167 offset:1024
  v_mfma_f32_32x32x16_bf16 v[32:47], v[144:147], v[100:103], v[32:47]
  global_load_dwordx4 v[88:91], v160, s[46:47] offset:1024 sc1
  global_load_dwordx4 v[92:95], v161, s[46:47] offset:1024 sc1
  v_mfma_f32_32x32x16_bf16 v[48:63], v[148:151], v[96:99], v[48:63]
  v_mfma_f32_32x32x16_bf16 v[64:79], v[148:151], v[100:103], v[64:79]
  s_waitcnt vmcnt(12)
  s_waitcnt lgkmcnt(0)
  v_mfma_f32_32x32x16_bf16 v[16:31], v[152:155], v[104:107], v[16:31]
  ds_read_b64_tr_b16 v[144:145], v166 offset:2048
  ds_read_b64_tr_b16 v[146:147], v166 offset:3072
  ds_read_b64_tr_b16 v[148:149], v167 offset:2048
  ds_read_b64_tr_b16 v[150:151], v167 offset:3072
  v_mfma_f32_32x32x16_bf16 v[32:47], v[152:155], v[108:111], v[32:47]
  global_load_dwordx4 v[96:99], v160, s[46:47] offset:2048 sc1
  global_load_dwordx4 v[100:103], v161, s[46:47] offset:2048 sc1
  v_mfma_f32_32x32x16_bf16 v[48:63], v[156:159], v[104:107], v[48:63]
  v_mfma_f32_32x32x16_bf16 v[64:79], v[156:159], v[108:111], v[64:79]
  s_waitcnt vmcnt(12)
  s_waitcnt lgkmcnt(0)
  v_mfma_f32_32x32x16_bf16 v[16:31], v[144:147], v[112:115], v[16:31]
  ds_read_b64_tr_b16 v[152:153], v166 offset:4096
  ds_read_b64_tr_b16 v[154:155], v166 offset:5120
  ds_read_b64_tr_b16 v[156:157], v167 offset:4096
  ds_read_b64_tr_b16 v[158:159], v167 offset:5120
  v_mfma_f32_32x32x16_bf16 v[32:47], v[144:147], v[116:119], v[32:47]
  global_load_dwordx4 v[104:107], v160, s[46:47] offset:3072 sc1
  global_load_dwordx4 v[108:111], v161, s[46:47] offset:3072 sc1
  v_mfma_f32_32x32x16_bf16 v[48:63], v[148:151], v[112:115], v[48:63]
  v_mfma_f32_32x32x16_bf16 v[64:79], v[148:151], v[116:119], v[64:79]
  s_waitcnt vmcnt(12)
  s_waitcnt lgkmcnt(0)
  v_mfma_f32_32x32x16_bf16 v[16:31], v[152:155], v[120:123], v[16:31]
  ds_read_b64_tr_b16 v[144:145], v166 offset:6144
  ds_read_b64_tr_b16 v[146:147], v166 offset:7168
  ds_read_b64_tr_b16 v[148:149], v167 offset:6144
  ds_read_b64_tr_b16 v[150:151], v167 offset:7168
  v_mfma_f32_32x32x16_bf16 v[32:47], v[152:155], v[124:127], v[32:47]
  v_add_u32 v162, s66, v160
  v_add_u32 v163, s66, v161
  global_load_dwordx4 v[112:115], v162, s[46:47] sc1
  global_load_dwordx4 v[116:119], v163, s[46:47] sc1
  v_mfma_f32_32x32x16_bf16 v[48:63], v[156:159], v[120:123], v[48:63]
  s_lshl_b32 s10, s4, 1
  s_add_u32 s10, s10, s79
  s_lshl_b32 s10, s10, 16
  s_lshl_b32 s11, s80, 13
  s_add_u32 s10, s10, s11
  s_add_u32 s10, s10, 4194304
  v_lshl_add_u32 v10, v0, 4, s10
  v_add_u32 v11, 4096, v10
  global_load_dwordx4 v[2:5], v10, s[46:47] sc1
  global_load_dwordx4 v[6:9], v11, s[46:47] sc1
  v_mfma_f32_32x32x16_bf16 v[64:79], v[156:159], v[124:127], v[64:79]
  s_waitcnt vmcnt(14)
  s_waitcnt lgkmcnt(0)
  v_mfma_f32_32x32x16_bf16 v[16:31], v[144:147], v[128:131], v[16:31]
  ds_read_b64_tr_b16 v[152:153], v166 offset:8192
  ds_read_b64_tr_b16 v[154:155], v166 offset:9216
  ds_read_b64_tr_b16 v[156:157], v167 offset:8192
  ds_read_b64_tr_b16 v[158:159], v167 offset:9216
  v_mfma_f32_32x32x16_bf16 v[32:47], v[144:147], v[132:135], v[32:47]
  v_add_u32 v162, s67, v160
  v_add_u32 v163, s67, v161
  global_load_dwordx4 v[120:123], v162, s[46:47] sc1
  global_load_dwordx4 v[124:127], v163, s[46:47] sc1
  v_mfma_f32_32x32x16_bf16 v[48:63], v[148:151], v[128:131], v[48:63]
  v_mfma_f32_32x32x16_bf16 v[64:79], v[148:151], v[132:135], v[64:79]
  s_waitcnt vmcnt(14)
  s_waitcnt lgkmcnt(0)
  v_mfma_f32_32x32x16_bf16 v[16:31], v[152:155], v[136:139], v[16:31]
  v_mfma_f32_32x32x16_bf16 v[32:47], v[152:155], v[140:143], v[32:47]
  v_mfma_f32_32x32x16_bf16 v[48:63], v[156:159], v[136:139], v[48:63]
  v_mfma_f32_32x32x16_bf16 v[64:79], v[156:159], v[140:143], v[64:79]
  s_waitcnt vmcnt(12)
  s_waitcnt lgkmcnt(0)
  v_mfma_f32_32x32x16_bf16 v[16:31], a[64:67], v[80:83], v[16:31]
  v_mfma_f32_32x32x16_bf16 v[32:47], a[64:67], v[84:87], v[32:47]
  v_mfma_f32_32x32x16_bf16 v[48:63], a[68:71], v[80:83], v[48:63]
  v_mfma_f32_32x32x16_bf16 v[64:79], a[68:71], v[84:87], v[64:79]
  s_waitcnt vmcnt(10)
  s_waitcnt lgkmcnt(0)
  v_mfma_f32_32x32x16_bf16 v[16:31], a[72:75], v[88:91], v[16:31]
  s_mul_i32 s10, s3, 8192
  s_add_u32 s10, s10, 82432
  v_add_u32 v166, s10, v173
  v_add_u32 v167, s10, v174
  ds_read_b64_tr_b16 v[144:145], v166 offset:0
  ds_read_b64_tr_b16 v[146:147], v166 offset:1024
  ds_read_b64_tr_b16 v[148:149], v167 offset:0
  ds_read_b64_tr_b16 v[150:151], v167 offset:1024
  v_mfma_f32_32x32x16_bf16 v[32:47], a[72:75], v[92:95], v[32:47]
  v_mfma_f32_32x32x16_bf16 v[48:63], a[76:79], v[88:91], v[48:63]
  s_barrier
  v_mfma_f32_32x32x16_bf16 v[64:79], a[76:79], v[92:95], v[64:79]
  s_waitcnt vmcnt(8)
  s_waitcnt lgkmcnt(0)
  v_mfma_f32_32x32x16_bf16 v[16:31], v[144:147], v[96:99], v[16:31]
  ds_read_b64_tr_b16 v[152:153], v166 offset:2048
  ds_read_b64_tr_b16 v[154:155], v166 offset:3072
  ds_read_b64_tr_b16 v[156:157], v167 offset:2048
  ds_read_b64_tr_b16 v[158:159], v167 offset:3072
  v_mfma_f32_32x32x16_bf16 v[32:47], v[144:147], v[100:103], v[32:47]
  v_mfma_f32_32x32x16_bf16 v[48:63], v[148:151], v[96:99], v[48:63]
  s_lshl_b32 s10, s4, 7
  s_lshl_b32 s11, s79, 6
  s_add_u32 s10, s10, s11
  s_and_b32 s11, s3, 1
  s_lshl_b32 s11, s11, 5
  s_add_u32 s10, s10, s11
  s_lshl_b32 s10, s10, 10
  s_lshl_b32 s11, s80, 7
  s_add_u32 s10, s10, s11
  s_lshr_b32 s11, s3, 1
  s_lshl_b32 s11, s11, 6
  s_add_u32 s10, s10, s11
  v_and_b32 v12, 31, v1
  v_lshlrev_b32 v12, 10, v12
  v_lshrrev_b32 v13, 5, v1
  v_lshl_add_u32 v12, v13, 3, v12
  v_add_u32 v14, s10, v12
  global_load_dwordx2 v[168:169], v14, s[16:17] offset:0
  global_load_dwordx2 v[170:171], v14, s[16:17] offset:16
  global_load_dwordx2 v[172:173], v14, s[16:17] offset:32
  global_load_dwordx2 v[174:175], v14, s[16:17] offset:48
  v_lshl_add_u32 v14, v13, 3, v14
  v_mfma_f32_32x32x16_bf16 v[64:79], v[148:151], v[100:103], v[64:79]
  s_waitcnt vmcnt(10)
  s_waitcnt lgkmcnt(0)
  v_mfma_f32_32x32x16_bf16 v[16:31], v[152:155], v[104:107], v[16:31]
  ds_read_b64_tr_b16 v[144:145], v166 offset:4096
  ds_read_b64_tr_b16 v[146:147], v166 offset:5120
  ds_read_b64_tr_b16 v[148:149], v167 offset:4096
  ds_read_b64_tr_b16 v[150:151], v167 offset:5120
  v_mfma_f32_32x32x16_bf16 v[32:47], v[152:155], v[108:111], v[32:47]
  v_mfma_f32_32x32x16_bf16 v[48:63], v[156:159], v[104:107], v[48:63]
  v_lshlrev_b32 v162, 4, v1
  s_mul_i32 s10, s3, 12288
  v_add_u32 v163, s10, v162
  v_lshrrev_b32 v12, 3, v0
  v_mul_u32_u24 v12, 192, v12
  v_and_b32 v13, 7, v0
  v_lshl_add_u32 v164, v13, 4, v12
  v_add_u32 v164, 49152, v164
  v_lshrrev_b32 v12, 4, v1
  v_and_b32 v13, 1, v12
  v_lshrrev_b32 v12, 1, v12
  v_bfe_u32 v165, v1, 2, 2
  v_lshl_add_u32 v165, v12, 2, v165
  v_mul_u32_u24 v165, 192, v165
  v_lshl_add_u32 v165, v13, 5, v165
  v_and_b32 v13, 3, v1
  v_lshl_add_u32 v165, v13, 3, v165
  s_lshr_b32 s10, s3, 1
  s_mul_i32 s10, s10, 6144
  s_and_b32 s11, s3, 1
  s_lshl_b32 s11, s11, 6
  s_add_u32 s10, s10, s11
  s_add_u32 s10, s10, 49152
  v_add_u32 v165, s10, v165
  v_mfma_f32_32x32x16_bf16 v[64:79], v[156:159], v[108:111], v[64:79]
  s_waitcnt vmcnt(8)
  s_waitcnt lgkmcnt(0)
  v_mfma_f32_32x32x16_bf16 v[16:31], v[144:147], v[112:115], v[16:31]
  ds_read_b64_tr_b16 v[152:153], v166 offset:6144
  ds_read_b64_tr_b16 v[154:155], v166 offset:7168
  ds_read_b64_tr_b16 v[156:157], v167 offset:6144
  ds_read_b64_tr_b16 v[158:159], v167 offset:7168
  v_mfma_f32_32x32x16_bf16 v[32:47], v[144:147], v[116:119], v[32:47]
  v_mfma_f32_32x32x16_bf16 v[48:63], v[148:151], v[112:115], v[48:63]
  v_mfma_f32_32x32x16_bf16 v[64:79], v[148:151], v[116:119], v[64:79]
  s_waitcnt vmcnt(4)
  s_waitcnt lgkmcnt(0)
  v_mfma_f32_32x32x16_bf16 v[16:31], v[152:155], v[120:123], v[16:31]
  v_mfma_f32_32x32x16_bf16 v[32:47], v[152:155], v[124:127], v[32:47]
  v_mfma_f32_32x32x16_bf16 v[48:63], v[156:159], v[120:123], v[48:63]
  v_mfma_f32_32x32x16_bf16 v[64:79], v[156:159], v[124:127], v[64:79]
  s_cmp_eq_u32 s3, 1
  s_cbranch_scc1 L_redw_11
  s_cmp_eq_u32 s3, 2
  s_cbranch_scc1 L_redw_12
  s_cmp_eq_u32 s3, 3
  s_cbranch_scc1 L_redw_13
L_redw_10:
  s_nop 9
  ds_write_b128 v162, v[32:35] offset:20480
  ds_write_b128 v162, v[36:39] offset:21504
  ds_write_b128 v162, v[40:43] offset:22528
  ds_write_b128 v162, v[44:47] offset:23552
  ds_write_b128 v162, v[48:51] offset:28672
  ds_write_b128 v162, v[52:55] offset:29696
  ds_write_b128 v162, v[56:59] offset:30720
  ds_write_b128 v162, v[60:63] offset:31744
  ds_write_b128 v162, v[64:67] offset:36864
  ds_write_b128 v162, v[68:71] offset:37888
  ds_write_b128 v162, v[72:75] offset:38912
  ds_write_b128 v162, v[76:79] offset:39936
  v_pk_mul_f32 v[80:81], v[16:17], 1.0 op_sel_hi:[1,0]
  v_pk_mul_f32 v[82:83], v[18:19], 1.0 op_sel_hi:[1,0]
  v_pk_mul_f32 v[84:85], v[20:21], 1.0 op_sel_hi:[1,0]
  v_pk_mul_f32 v[86:87], v[22:23], 1.0 op_sel_hi:[1,0]
  v_pk_mul_f32 v[88:89], v[24:25], 1.0 op_sel_hi:[1,0]
  v_pk_mul_f32 v[90:91], v[26:27], 1.0 op_sel_hi:[1,0]
  v_pk_mul_f32 v[92:93], v[28:29], 1.0 op_sel_hi:[1,0]
  v_pk_mul_f32 v[94:95], v[30:31], 1.0 op_sel_hi:[1,0]
  s_branch L_redend_9
L_redw_11:
  s_nop 9
  ds_write_b128 v162, v[16:19] offset:0
  ds_write_b128 v162, v[20:23] offset:1024
  ds_write_b128 v162, v[24:27] offset:2048
  ds_write_b128 v162, v[28:31] offset:3072
  ds_write_b128 v162, v[48:51] offset:32768
  ds_write_b128 v162, v[52:55] offset:33792
  ds_write_b128 v162, v[56:59] offset:34816
  ds_write_b128 v162, v[60:63] offset:35840
  ds_write_b128 v162, v[64:67] offset:40960
  ds_write_b128 v162, v[68:71] offset:41984
  ds_write_b128 v162, v[72:75] offset:43008
  ds_write_b128 v162, v[76:79] offset:44032
  v_pk_mul_f32 v[80:81], v[32:33], 1.0 op_sel_hi:[1,0]
  v_pk_mul_f32 v[82:83], v[34:35], 1.0 op_sel_hi:[1,0]
  v_pk_mul_f32 v[84:85], v[36:37], 1.0 op_sel_hi:[1,0]
  v_pk_mul_f32 v[86:87], v[38:39], 1.0 op_sel_hi:[1,0]
  v_pk_mul_f32 v[88:89], v[40:41], 1.0 op_sel_hi:[1,0]
  v_pk_mul_f32 v[90:91], v[42:43], 1.0 op_sel_hi:[1,0]
  v_pk_mul_f32 v[92:93], v[44:45], 1.0 op_sel_hi:[1,0]
  v_pk_mul_f32 v[94:95], v[46:47], 1.0 op_sel_hi:[1,0]
  s_branch L_redend_9
L_redw_12:
  s_nop 9
  ds_write_b128 v162, v[16:19] offset:4096
  ds_write_b128 v162, v[20:23] offset:5120
  ds_write_b128 v162, v[24:27] offset:6144
  ds_write_b128 v162, v[28:31] offset:7168
  ds_write_b128 v162, v[32:35] offset:12288
  ds_write_b128 v162, v[36:39] offset:13312
  ds_write_b128 v162, v[40:43] offset:14336
  ds_write_b128 v162, v[44:47] offset:15360
  ds_write_b128 v162, v[64:67] offset:45056
  ds_write_b128 v162, v[68:71] offset:46080
  ds_write_b128 v162, v[72:75] offset:47104
  ds_write_b128 v162, v[76:79] offset:48128
  v_pk_mul_f32 v[80:81], v[48:49], 1.0 op_sel_hi:[1,0]
  v_pk_mul_f32 v[82:83], v[50:51], 1.0 op_sel_hi:[1,0]
  v_pk_mul_f32 v[84:85], v[52:53], 1.0 op_sel_hi:[1,0]
  v_pk_mul_f32 v[86:87], v[54:55], 1.0 op_sel_hi:[1,0]
  v_pk_mul_f32 v[88:89], v[56:57], 1.0 op_sel_hi:[1,0]
  v_pk_mul_f32 v[90:91], v[58:59], 1.0 op_sel_hi:[1,0]
  v_pk_mul_f32 v[92:93], v[60:61], 1.0 op_sel_hi:[1,0]
  v_pk_mul_f32 v[94:95], v[62:63], 1.0 op_sel_hi:[1,0]
  s_branch L_redend_9
L_redw_13:
  s_nop 9
  ds_write_b128 v162, v[16:19] offset:8192
  ds_write_b128 v162, v[20:23] offset:9216
  ds_write_b128 v162, v[24:27] offset:10240
  ds_write_b128 v162, v[28:31] offset:11264
  ds_write_b128 v162, v[32:35] offset:16384
  ds_write_b128 v162, v[36:39] offset:17408
  ds_write_b128 v162, v[40:43] offset:18432
  ds_write_b128 v162, v[44:47] offset:19456
  ds_write_b128 v162, v[48:51] offset:24576
  ds_write_b128 v162, v[52:55] offset:25600
  ds_write_b128 v162, v[56:59] offset:26624
  ds_write_b128 v162, v[60:63] offset:27648
  v_pk_mul_f32 v[80:81], v[64:65], 1.0 op_sel_hi:[1,0]
  v_pk_mul_f32 v[82:83], v[66:67], 1.0 op_sel_hi:[1,0]
  v_pk_mul_f32 v[84:85], v[68:69], 1.0 op_sel_hi:[1,0]
  v_pk_mul_f32 v[86:87], v[70:71], 1.0 op_sel_hi:[1,0]
  v_pk_mul_f32 v[88:89], v[72:73], 1.0 op_sel_hi:[1,0]
  v_pk_mul_f32 v[90:91], v[74:75], 1.0 op_sel_hi:[1,0]
  v_pk_mul_f32 v[92:93], v[76:77], 1.0 op_sel_hi:[1,0]
  v_pk_mul_f32 v[94:95], v[78:79], 1.0 op_sel_hi:[1,0]
L_redend_9:
  s_mov_b32 s13, 0
L_ychk_14:
  v_max3_u32 v12, v2, v3, v4
  v_max3_u32 v13, v5, v6, v7
  v_max3_u32 v12, v12, v8, v9
  v_max_u32 v12, v12, v13
  v_cmp_eq_u32 vcc, -1, v12
  s_nop 1
  s_cmp_eq_u64 vcc, 0
  s_cbranch_scc1 L_yok_15
  s_add_u32 s13, s13, 1
  s_cmp_gt_u32 s13, 131072
  s_cbranch_scc1 L_yok_15
  s_sleep 8
  global_load_dwordx4 v[2:5], v10, s[46:47] sc1
  global_load_dwordx4 v[6:9], v11, s[46:47] sc1
  s_waitcnt vmcnt(0)
  s_branch L_ychk_14
L_yok_15:
  ds_write_b128 v164, v[2:5]
  ds_write_b128 v164, v[6:9] offset:6144
  s_waitcnt vmcnt(0)
  v_lshlrev_b32 v96, 16, v168
  v_and_b32 v97, 0xffff0000, v168
  v_lshlrev_b32 v98, 16, v169
  v_and_b32 v99, 0xffff0000, v169
  v_lshlrev_b32 v100, 16, v170
  v_and_b32 v101, 0xffff0000, v170
  v_lshlrev_b32 v102, 16, v171
  v_and_b32 v103, 0xffff0000, v171
  v_lshlrev_b32 v104, 16, v172
  v_and_b32 v105, 0xffff0000, v172
  v_lshlrev_b32 v106, 16, v173
  v_and_b32 v107, 0xffff0000, v173
  v_lshlrev_b32 v108, 16, v174
  v_and_b32 v109, 0xffff0000, v174
  v_lshlrev_b32 v110, 16, v175
  v_and_b32 v111, 0xffff0000, v175
  v_pk_add_f32 v[80:81], v[80:81], v[96:97]
  v_pk_add_f32 v[82:83], v[82:83], v[98:99]
  v_pk_add_f32 v[84:85], v[84:85], v[100:101]
  v_pk_add_f32 v[86:87], v[86:87], v[102:103]
  v_pk_add_f32 v[88:89], v[88:89], v[104:105]
  v_pk_add_f32 v[90:91], v[90:91], v[106:107]
  v_pk_add_f32 v[92:93], v[92:93], v[108:109]
  v_pk_add_f32 v[94:95], v[94:95], v[110:111]
  s_waitcnt lgkmcnt(0)
  s_barrier
  ds_read_b64_tr_b16 v[2:3], v165 offset:0
  ds_read_b64_tr_b16 v[4:5], v165 offset:1536
  ds_read_b64_tr_b16 v[6:7], v165 offset:3072
  ds_read_b64_tr_b16 v[8:9], v165 offset:4608
  ds_read_b128 v[112:115], v163 offset:0
  ds_read_b128 v[116:119], v163 offset:1024
  ds_read_b128 v[120:123], v163 offset:2048
  ds_read_b128 v[124:127], v163 offset:3072
  ds_read_b128 v[128:131], v163 offset:4096
  ds_read_b128 v[132:135], v163 offset:5120
  ds_read_b128 v[136:139], v163 offset:6144
  ds_read_b128 v[140:143], v163 offset:7168
  ds_read_b128 v[144:147], v163 offset:8192
  ds_read_b128 v[148:151], v163 offset:9216
  ds_read_b128 v[152:155], v163 offset:10240
  ds_read_b128 v[156:159], v163 offset:11264
  s_waitcnt lgkmcnt(12)
  v_lshlrev_b32 v96, 16, v2
  v_and_b32 v97, 0xffff0000, v2
  v_lshlrev_b32 v98, 16, v3
  v_and_b32 v99, 0xffff0000, v3
  v_lshlrev_b32 v100, 16, v4
  v_and_b32 v101, 0xffff0000, v4
  v_lshlrev_b32 v102, 16, v5
  v_and_b32 v103, 0xffff0000, v5
  v_lshlrev_b32 v104, 16, v6
  v_and_b32 v105, 0xffff0000, v6
  v_lshlrev_b32 v106, 16, v7
  v_and_b32 v107, 0xffff0000, v7
  v_lshlrev_b32 v108, 16, v8
  v_and_b32 v109, 0xffff0000, v8
  v_lshlrev_b32 v110, 16, v9
  v_and_b32 v111, 0xffff0000, v9
  v_pk_add_f32 v[80:81], v[80:81], v[96:97]
  v_pk_add_f32 v[82:83], v[82:83], v[98:99]
  v_pk_add_f32 v[84:85], v[84:85], v[100:101]
  v_pk_add_f32 v[86:87], v[86:87], v[102:103]
  v_pk_add_f32 v[88:89], v[88:89], v[104:105]
  v_pk_add_f32 v[90:91], v[90:91], v[106:107]
  v_pk_add_f32 v[92:93], v[92:93], v[108:109]
  v_pk_add_f32 v[94:95], v[94:95], v[110:111]
  s_waitcnt lgkmcnt(8)
  v_pk_add_f32 v[80:81], v[80:81], v[112:113]
  v_pk_add_f32 v[82:83], v[82:83], v[114:115]
  v_pk_add_f32 v[84:85], v[84:85], v[116:117]
  v_pk_add_f32 v[86:87], v[86:87], v[118:119]
  v_pk_add_f32 v[88:89], v[88:89], v[120:121]
  v_pk_add_f32 v[90:91], v[90:91], v[122:123]
  v_pk_add_f32 v[92:93], v[92:93], v[124:125]
  v_pk_add_f32 v[94:95], v[94:95], v[126:127]
  s_waitcnt lgkmcnt(4)
  v_pk_add_f32 v[80:81], v[80:81], v[128:129]
  v_pk_add_f32 v[82:83], v[82:83], v[130:131]
  v_pk_add_f32 v[84:85], v[84:85], v[132:133]
  v_pk_add_f32 v[86:87], v[86:87], v[134:135]
  v_pk_add_f32 v[88:89], v[88:89], v[136:137]
  v_pk_add_f32 v[90:91], v[90:91], v[138:139]
  v_pk_add_f32 v[92:93], v[92:93], v[140:141]
  v_pk_add_f32 v[94:95], v[94:95], v[142:143]
  s_waitcnt lgkmcnt(0)
  v_pk_add_f32 v[80:81], v[80:81], v[144:145]
  v_pk_add_f32 v[82:83], v[82:83], v[146:147]
  v_pk_add_f32 v[84:85], v[84:85], v[148:149]
  v_pk_add_f32 v[86:87], v[86:87], v[150:151]
  v_pk_add_f32 v[88:89], v[88:89], v[152:153]
  v_pk_add_f32 v[90:91], v[90:91], v[154:155]
  v_pk_add_f32 v[92:93], v[92:93], v[156:157]
  v_pk_add_f32 v[94:95], v[94:95], v[158:159]
  v_cvt_pk_bf16_f32 v2, v80, v81
  v_cvt_pk_bf16_f32 v3, v82, v83
  v_cvt_pk_bf16_f32 v4, v84, v85
  v_cvt_pk_bf16_f32 v5, v86, v87
  v_cvt_pk_bf16_f32 v6, v88, v89
  v_cvt_pk_bf16_f32 v7, v90, v91
  v_cvt_pk_bf16_f32 v8, v92, v93
  v_cvt_pk_bf16_f32 v9, v94, v95
  s_nop 1
  v_permlane32_swap_b32 v2, v4
  v_permlane32_swap_b32 v3, v5
  v_permlane32_swap_b32 v6, v8
  v_permlane32_swap_b32 v7, v9
  global_store_dwordx4 v14, v[2:5], s[42:43] offset:0 nt
  global_store_dwordx4 v14, v[6:9], s[42:43] offset:32 nt
  s_waitcnt vmcnt(0)
  s_endpgm

L_role_c:
  s_lshl_b32 s10, s4, 7
  s_lshl_b32 s11, s3, 5
  s_add_u32 s10, s10, s11
  s_lshl_b32 s64, s10, 10
  s_lshl_b32 s68, s3, 12
  s_add_u32 s9, s4, s5
  s_and_b32 s9, s9, 7
  s_mul_i32 s65, s3, 44032
  s_lshl_b32 s10, s8, 6
  s_add_u32 s65, s65, s10
  s_mul_i32 s69, s3, 3072
  v_lshrrev_b32 v12, 3, v1
  v_and_b32 v13, 7, v1
  v_lshrrev_b32 v14, 1, v12
  v_xor_b32 v15, v14, v13
  v_lshlrev_b32 v16, 4, v15
  v_lshl_add_u32 v2, v12, 10, v16
  v_xor_b32 v17, 64, v2
  v_add_u32 v3, 8192, v17
  v_add_u32 v4, 16384, v2
  v_add_u32 v5, 16384, v3
  v_add_u32 v12, 0, v1
  v_mul_u32_u24 v13, 5462, v12
  v_lshrrev_b32 v13, 16, v13
  v_mul_u32_u24 v14, 12, v13
  v_sub_u32 v14, v12, v14
  v_mul_u32_u24 v13, 2752, v13
  v_lshl_add_u32 v6, v14, 4, v13
  v_add_u32 v12, 64, v1
  v_mul_u32_u24 v13, 5462, v12
  v_lshrrev_b32 v13, 16, v13
  v_mul_u32_u24 v14, 12, v13
  v_sub_u32 v14, v12, v14
  v_mul_u32_u24 v13, 2752, v13
  v_lshl_add_u32 v7, v14, 4, v13
  v_add_u32 v12, 128, v1
  v_mul_u32_u24 v13, 5462, v12
  v_lshrrev_b32 v13, 16, v13
  v_mul_u32_u24 v14, 12, v13
  v_sub_u32 v14, v12, v14
  v_mul_u32_u24 v13, 2752, v13
  v_lshl_add_u32 v8, v14, 4, v13
  v_lshrrev_b32 v12, 4, v1
  v_and_b32 v13, 1, v12
  v_lshrrev_b32 v12, 1, v12
  v_bfe_u32 v14, v1, 2, 2
  v_lshl_add_u32 v14, v12, 3, v14
  v_mul_u32_u24 v14, 192, v14
  v_and_b32 v15, 3, v1
  v_lshl_add_u32 v14, v15, 3, v14
  v_mul_u32_u24 v13, 12320, v13
  v_add_u32 v14, v14, v13
  s_mul_i32 s10, s7, 96
  s_add_u32 s10, s10, 16384
  v_add_u32 v9, s10, v14
  s_waitcnt lgkmcnt(0)
  s_mov_b32 s35, 1
  s_mov_b32 s48, s16
  s_and_b32 s49, s17, 0xffff
  s_mov_b32 s50, 2097152
  s_mov_b32 s51, 0x20000
  s_mov_b32 s52, s36
  s_and_b32 s53, s37, 0xffff
  s_mov_b32 s54, 1409024
  s_mov_b32 s55, 0x20000
  s_mov_b32 s56, s38
  s_and_b32 s57, s39, 0xffff
  s_mov_b32 s58, 1409024
  s_mov_b32 s59, 0x20000
  v_mov_b32 v13, 0
  global_load_dword v54, v13, s[46:47] sc1
  s_lshl_b32 s66, s9, 7
  s_add_u32 s66, s66, s64
  s_mul_i32 s67, s9, 176128
  s_add_u32 s67, s67, s65
  s_add_u32 s9, s9, 1
  s_and_b32 s9, s9, 7
  s_add_u32 m0, s68, 0
  s_nop 0
  buffer_load_dwordx4 v2, s[48:51], s66 offen lds
  s_add_u32 m0, s68, 1024
  s_nop 0
  buffer_load_dwordx4 v3, s[48:51], s66 offen lds
  s_add_u32 m0, s68, 2048
  s_nop 0
  buffer_load_dwordx4 v4, s[48:51], s66 offen lds
  s_add_u32 m0, s68, 3072
  s_nop 0
  buffer_load_dwordx4 v5, s[48:51], s66 offen lds
  s_add_u32 m0, s69, 16384
  s_nop 0
  buffer_load_dwordx4 v6, s[52:55], s67 offen lds
  s_add_u32 m0, s69, 28704
  s_nop 0
  buffer_load_dwordx4 v6, s[56:59], s67 offen lds
  s_add_u32 m0, s69, 17408
  s_nop 0
  buffer_load_dwordx4 v7, s[52:55], s67 offen lds
  s_add_u32 m0, s69, 29728
  s_nop 0
  buffer_load_dwordx4 v7, s[56:59], s67 offen lds
  s_add_u32 m0, s69, 18432
  s_nop 0
  buffer_load_dwordx4 v8, s[52:55], s67 offen lds
  s_add_u32 m0, s69, 30752
  s_nop 0
  buffer_load_dwordx4 v8, s[56:59], s67 offen lds
  s_lshl_b32 s66, s9, 7
  s_add_u32 s66, s66, s64
  s_mul_i32 s67, s9, 176128
  s_add_u32 s67, s67, s65
  s_add_u32 s9, s9, 1
  s_and_b32 s9, s9, 7
  s_add_u32 m0, s68, 41216
  s_nop 0
  buffer_load_dwordx4 v2, s[48:51], s66 offen lds
  s_add_u32 m0, s68, 42240
  s_nop 0
  buffer_load_dwordx4 v3, s[48:51], s66 offen lds
  s_add_u32 m0, s68, 43264
  s_nop 0
  buffer_load_dwordx4 v4, s[48:51], s66 offen lds
  s_add_u32 m0, s68, 44288
  s_nop 0
  buffer_load_dwordx4 v5, s[48:51], s66 offen lds
  s_waitcnt vmcnt(4)
  s_barrier
  s_add_u32 m0, s69, 57600
  s_nop 0
  buffer_load_dwordx4 v6, s[52:55], s67 offen lds
  s_add_u32 m0, s69, 69920
  s_nop 0
  buffer_load_dwordx4 v6, s[56:59], s67 offen lds
  s_add_u32 m0, s69, 58624
  s_nop 0
  buffer_load_dwordx4 v7, s[52:55], s67 offen lds
  s_add_u32 m0, s69, 70944
  s_nop 0
  buffer_load_dwordx4 v7, s[56:59], s67 offen lds
  s_add_u32 m0, s69, 59648
  s_nop 0
  buffer_load_dwordx4 v8, s[52:55], s67 offen lds
  s_add_u32 m0, s69, 71968
  s_nop 0
  buffer_load_dwordx4 v8, s[56:59], s67 offen lds
  s_nop 0
  v_readfirstlane_b32 s34, v54
  s_nop 3
  s_mul_i32 s14, s34, 0x9e3779b1
  s_add_u32 s14, s14, 0x3c6ef373
  s_cmp_lg_u32 s73, 0
  s_cbranch_scc1 L_nocs_16
  v_mov_b32 v60, 0x3f803f80
  v_mov_b32 v61, 0x3f803f80
  v_mov_b32 v62, 0x3f803f80
  v_mov_b32 v63, 0x3f803f80
  ds_read_b64_tr_b16 v[64:65], v9 offset:0
  ds_read_b64_tr_b16 v[66:67], v9 offset:768
  ds_read_b64_tr_b16 v[68:69], v9 offset:32
  ds_read_b64_tr_b16 v[70:71], v9 offset:800
  ds_read_b64_tr_b16 v[72:73], v9 offset:64
  ds_read_b64_tr_b16 v[74:75], v9 offset:832
  ds_read_b64_tr_b16 v[76:77], v9 offset:3072
  ds_read_b64_tr_b16 v[78:79], v9 offset:3840
  ds_read_b64_tr_b16 v[80:81], v9 offset:3104
  ds_read_b64_tr_b16 v[82:83], v9 offset:3872
  ds_read_b64_tr_b16 v[84:85], v9 offset:3136
  ds_read_b64_tr_b16 v[86:87], v9 offset:3904
  ds_read_b64_tr_b16 v[88:89], v9 offset:6144
  ds_read_b64_tr_b16 v[90:91], v9 offset:6912
  ds_read_b64_tr_b16 v[92:93], v9 offset:6176
  ds_read_b64_tr_b16 v[94:95], v9 offset:6944
  ds_read_b64_tr_b16 v[96:97], v9 offset:6208
  ds_read_b64_tr_b16 v[98:99], v9 offset:6976
  ds_read_b64_tr_b16 v[100:101], v9 offset:9216
  ds_read_b64_tr_b16 v[102:103], v9 offset:9984
  ds_read_b64_tr_b16 v[104:105], v9 offset:9248
  ds_read_b64_tr_b16 v[106:107], v9 offset:10016
  ds_read_b64_tr_b16 v[108:109], v9 offset:9280
  ds_read_b64_tr_b16 v[110:111], v9 offset:10048
  s_waitcnt lgkmcnt(0)
  v_mfma_f32_32x32x16_bf16 v[112:127], v[60:63], v[64:67], 0
  v_mfma_f32_32x32x16_bf16 v[128:143], v[60:63], v[68:71], 0
  v_mfma_f32_32x32x16_bf16 v[144:159], v[60:63], v[72:75], 0
  v_mfma_f32_32x32x16_bf16 v[112:127], v[60:63], v[76:79], v[112:127]
  v_mfma_f32_32x32x16_bf16 v[128:143], v[60:63], v[80:83], v[128:143]
  v_mfma_f32_32x32x16_bf16 v[144:159], v[60:63], v[84:87], v[144:159]
  v_mfma_f32_32x32x16_bf16 v[112:127], v[60:63], v[88:91], v[112:127]
  v_mfma_f32_32x32x16_bf16 v[128:143], v[60:63], v[92:95], v[128:143]
  v_mfma_f32_32x32x16_bf16 v[144:159], v[60:63], v[96:99], v[144:159]
  v_mfma_f32_32x32x16_bf16 v[112:127], v[60:63], v[100:103], v[112:127]
  v_mfma_f32_32x32x16_bf16 v[128:143], v[60:63], v[104:107], v[128:143]
  v_mfma_f32_32x32x16_bf16 v[144:159], v[60:63], v[108:111], v[144:159]
  s_mul_i32 s10, s5, 6
  s_mul_i32 s11, s7, 3
  s_add_u32 s10, s10, s11
  s_lshl_b32 s10, s10, 10
  s_lshl_b32 s11, s4, 2
  s_add_u32 s10, s10, s11
  s_add_u32 s10, s10, 131072
  v_lshl_add_u32 v59, v1, 5, s10
  s_cmp_ge_u32 s3, 2
  s_cbranch_scc1 L_nocsst_17
  s_nop 7
  s_mov_b64 s[70:71], exec
  s_mov_b64 exec, 0xffffffff
  global_store_dword v59, v112, s[46:47] offset:0 sc1
  global_store_dword v59, v128, s[46:47] offset:1024 sc1
  global_store_dword v59, v144, s[46:47] offset:2048 sc1
  s_mov_b64 exec, s[70:71]
L_nocsst_17:
L_nocs_16:
  s_lshl_b32 s66, s9, 7
  s_add_u32 s66, s66, s64
  s_mul_i32 s67, s9, 176128
  s_add_u32 s67, s67, s65
  s_add_u32 s9, s9, 1
  s_and_b32 s9, s9, 7
  s_add_u32 m0, s68, 82432
  s_nop 0
  buffer_load_dwordx4 v2, s[48:51], s66 offen lds
  s_add_u32 m0, s68, 83456
  s_nop 0
  buffer_load_dwordx4 v3, s[48:51], s66 offen lds
  s_add_u32 m0, s68, 84480
  s_nop 0
  buffer_load_dwordx4 v4, s[48:51], s66 offen lds
  s_add_u32 m0, s68, 85504
  s_nop 0
  buffer_load_dwordx4 v5, s[48:51], s66 offen lds
  s_add_u32 m0, s69, 98816
  s_nop 0
  buffer_load_dwordx4 v6, s[52:55], s67 offen lds
  s_add_u32 m0, s69, 111136
  s_nop 0
  buffer_load_dwordx4 v6, s[56:59], s67 offen lds
  s_add_u32 m0, s69, 99840
  s_nop 0
  buffer_load_dwordx4 v7, s[52:55], s67 offen lds
  s_add_u32 m0, s69, 112160
  s_nop 0
  buffer_load_dwordx4 v7, s[56:59], s67 offen lds
  s_add_u32 m0, s69, 100864
  s_nop 0
  buffer_load_dwordx4 v8, s[52:55], s67 offen lds
  s_add_u32 m0, s69, 113184
  s_nop 0
  buffer_load_dwordx4 v8, s[56:59], s67 offen lds
  s_lshl_b32 s10, s76, 8
  s_lshl_b32 s11, s78, 7
  s_add_u32 s10, s10, s11
  v_lshl_add_u32 v12, v1, 1, s10
  global_load_ushort v160, v12, s[18:19]
  global_load_ushort v161, v12, s[20:21]
  global_load_ushort v162, v12, s[22:23]
  global_load_ushort v163, v12, s[24:25]
  global_load_ushort v164, v12, s[26:27]
  global_load_ushort v165, v12, s[28:29]
  s_lshl_b32 s10, s76, 1
  v_mov_b32 v13, s10
  global_load_ushort v166, v13, s[30:31]
  global_load_ushort v167, v13, s[32:33]
  s_waitcnt lgkmcnt(0)
  s_waitcnt vmcnt(18)
  s_barrier
  s_lshl_b32 s66, s9, 7
  s_add_u32 s66, s66, s64
  s_mul_i32 s67, s9, 176128
  s_add_u32 s67, s67, s65
  s_add_u32 s9, s9, 1
  s_and_b32 s9, s9, 7
  s_add_u32 m0, s68, 0
  s_nop 0
  buffer_load_dwordx4 v2, s[48:51], s66 offen lds
  s_add_u32 m0, s68, 1024
  s_nop 0
  buffer_load_dwordx4 v3, s[48:51], s66 offen lds
  s_add_u32 m0, s68, 2048
  s_nop 0
  buffer_load_dwordx4 v4, s[48:51], s66 offen lds
  s_add_u32 m0, s68, 3072
  s_nop 0
  buffer_load_dwordx4 v5, s[48:51], s66 offen lds
  s_add_u32 m0, s69, 16384
  s_nop 0
  buffer_load_dwordx4 v6, s[52:55], s67 offen lds
  s_add_u32 m0, s69, 28704
  s_nop 0
  buffer_load_dwordx4 v6, s[56:59], s67 offen lds
  s_add_u32 m0, s69, 17408
  s_nop 0
  buffer_load_dwordx4 v7, s[52:55], s67 offen lds
  s_add_u32 m0, s69, 29728
  s_nop 0
  buffer_load_dwordx4 v7, s[56:59], s67 offen lds
  s_add_u32 m0, s69, 18432
  s_nop 0
  buffer_load_dwordx4 v8, s[52:55], s67 offen lds
  s_add_u32 m0, s69, 30752
  s_nop 0
  buffer_load_dwordx4 v8, s[56:59], s67 offen lds
  s_waitcnt lgkmcnt(0)
  s_waitcnt vmcnt(18)
  s_barrier
  s_lshl_b32 s66, s9, 7
  s_add_u32 s66, s66, s64
  s_mul_i32 s67, s9, 176128
  s_add_u32 s67, s67, s65
  s_add_u32 s9, s9, 1
  s_and_b32 s9, s9, 7
  s_add_u32 m0, s68, 41216
  s_nop 0
  buffer_load_dwordx4 v2, s[48:51], s66 offen lds
  s_waitcnt vmcnt(11)
  v_lshlrev_b32 v160, 16, v160
  v_lshlrev_b32 v161, 16, v161
  v_lshlrev_b32 v162, 16, v162
  v_lshlrev_b32 v163, 16, v163
  v_lshlrev_b32 v164, 16, v164
  v_lshlrev_b32 v165, 16, v165
  v_lshlrev_b32 v166, 16, v166
  s_add_u32 m0, s68, 42240
  s_nop 0
  buffer_load_dwordx4 v3, s[48:51], s66 offen lds
  v_lshlrev_b32 v167, 16, v167
  v_mul_f32 v58, 0x3fb8aa3b, v166
  v_exp_f32 v58, v58
  v_mov_b32 v26, 1.0
  v_cvt_pk_bf16_f32 v58, v58, v58
  v_mov_b32 v27, 0
  v_lshlrev_b32 v58, 16, v58
  v_mul_f32 v10, v58, v160
  s_add_u32 m0, s68, 43264
  s_nop 0
  buffer_load_dwordx4 v4, s[48:51], s66 offen lds
  v_mul_f32 v11, v58, v161
  v_mul_f32 v56, v58, v162
  v_mul_f32 v57, v58, v163
  v_mul_f32 v10, 0x3fb8aa3b, v10
  v_mul_f32 v11, 0.15915494, v11
  v_mul_f32 v12, v164, v56
  v_mul_f32 v13, v164, v57
  v_fma_f32 v12, -v165, v57, v12
  s_add_u32 m0, s68, 44288
  s_nop 0
  buffer_load_dwordx4 v5, s[48:51], s66 offen lds
  v_fma_f32 v13, v165, v56, v13
  v_mul_f32 v48, 0x3f800000, v10
  v_mul_f32 v49, 0x3f800000, v11
  v_mul_f32 v50, 0x41000000, v10
  v_mul_f32 v51, 0x41000000, v11
  v_mul_f32 v52, 0x43800000, v10
  v_mul_f32 v53, 0x43800000, v11
  v_mul_f32 v54, 0x43000000, v10
  s_add_u32 m0, s69, 57600
  s_nop 0
  buffer_load_dwordx4 v6, s[52:55], s67 offen lds
  v_mul_f32 v55, 0x43000000, v11
  v_exp_f32 v48, v48
  v_fract_f32 v49, v49
  v_exp_f32 v50, v50
  v_fract_f32 v51, v51
  v_exp_f32 v52, v52
  v_fract_f32 v53, v53
  v_exp_f32 v54, v54
  s_add_u32 m0, s69, 69920
  s_nop 0
  buffer_load_dwordx4 v6, s[56:59], s67 offen lds
  v_fract_f32 v55, v55
  v_cos_f32 v14, v49
  v_sin_f32 v15, v49
  v_cos_f32 v20, v51
  v_sin_f32 v21, v51
  v_cos_f32 v22, v53
  v_sin_f32 v23, v53
  v_cos_f32 v30, v55
  s_add_u32 m0, s69, 58624
  s_nop 0
  buffer_load_dwordx4 v7, s[52:55], s67 offen lds
  v_sin_f32 v31, v55
  v_nop
  v_mul_f32 v14, v14, v48
  v_mul_f32 v15, v15, v48
  v_mul_f32 v20, v20, v50
  v_mul_f32 v21, v21, v50
  v_mul_f32 v22, v22, v52
  v_mul_f32 v23, v23, v52
  s_add_u32 m0, s69, 70944
  s_nop 0
  buffer_load_dwordx4 v7, s[56:59], s67 offen lds
  v_mul_f32 v30, v30, v54
  v_mul_f32 v31, v31, v54
  v_mul_f32 v16, v14, v14
  v_mul_f32 v17, v14, v15
  v_fma_f32 v16, -v15, v15, v16
  v_fma_f32 v17, v15, v14, v17
  v_mul_f32 v24, v22, v22
  v_mul_f32 v25, v22, v23
  s_add_u32 m0, s69, 59648
  s_nop 0
  buffer_load_dwordx4 v8, s[52:55], s67 offen lds
  v_fma_f32 v24, -v23, v23, v24
  v_fma_f32 v25, v23, v22, v25
  v_mul_f32 v38, v12, v22
  v_mul_f32 v39, v12, v23
  v_fma_f32 v38, -v13, v23, v38
  v_fma_f32 v39, v13, v22, v39
  v_mul_f32 v18, v16, v16
  v_mul_f32 v19, v16, v17
  s_add_u32 m0, s69, 71968
  s_nop 0
  buffer_load_dwordx4 v8, s[56:59], s67 offen lds
  v_fma_f32 v18, -v17, v17, v18
  v_fma_f32 v19, v17, v16, v19
  v_mul_f32 v44, v12, v24
  v_mul_f32 v45, v12, v25
  v_fma_f32 v44, -v13, v25, v44
  v_fma_f32 v45, v13, v24, v45
  v_cvt_pk_bf16_f32 v96, v26, v27
  v_cvt_pk_bf16_f32 v112, v30, v31
  v_cvt_pk_bf16_f32 v64, v12, -v13
  v_cvt_pk_bf16_f32 v80, v44, -v45
  v_mul_f32 v28, v26, v20
  v_mul_f32 v29, v26, v21
  v_fma_f32 v28, -v27, v21, v28
  v_fma_f32 v29, v27, v20, v29
  v_mul_f32 v32, v30, v20
  v_mul_f32 v33, v30, v21
  v_fma_f32 v32, -v31, v21, v32
  s_waitcnt lgkmcnt(0)
  s_waitcnt vmcnt(10)
  s_barrier
  s_mul_i32 s10, s2, 5504
  s_lshl_b32 s11, s3, 10
  s_add_u32 s10, s10, s11
  v_lshl_add_u32 v52, v1, 4, s10
  s_mov_b32 s60, s40
  s_and_b32 s61, s41, 0xffff
  s_mov_b32 s62, 1409024
  s_mov_b32 s63, 0x20000
  buffer_load_dwordx4 v[136:139], v52, s[60:63], 0 offen
  v_add_u32 v52, 4096, v52
  buffer_load_dwordx4 v[136:139], v52, s[60:63], 0 offen
  s_lshl_b32 s66, s9, 7
  s_add_u32 s66, s66, s64
  s_mul_i32 s67, s9, 176128
  s_add_u32 s67, s67, s65
  s_add_u32 s9, s9, 1
  s_and_b32 s9, s9, 7
  s_add_u32 m0, s68, 82432
  s_nop 0
  buffer_load_dwordx4 v2, s[48:51], s66 offen lds
  v_fma_f32 v33, v31, v20, v33
  v_mul_f32 v36, v12, v14
  v_mul_f32 v37, v12, v15
  v_fma_f32 v36, -v13, v15, v36
  v_fma_f32 v37, v13, v14, v37
  v_mul_f32 v40, v44, v18
  v_mul_f32 v41, v44, v19
  v_fma_f32 v40, -v45, v19, v40
  s_add_u32 m0, s68, 83456
  s_nop 0
  buffer_load_dwordx4 v3, s[48:51], s66 offen lds
  v_fma_f32 v41, v45, v18, v41
  v_cvt_pk_bf16_f32 v97, v28, v29
  v_cvt_pk_bf16_f32 v113, v32, v33
  v_cvt_pk_bf16_f32 v65, v36, -v37
  v_cvt_pk_bf16_f32 v81, v40, -v41
  v_mul_f32 v26, v28, v20
  v_mul_f32 v27, v28, v21
  v_fma_f32 v26, -v29, v21, v26
  s_add_u32 m0, s68, 84480
  s_nop 0
  buffer_load_dwordx4 v4, s[48:51], s66 offen lds
  v_fma_f32 v27, v29, v20, v27
  v_mul_f32 v30, v32, v20
  v_mul_f32 v31, v32, v21
  v_fma_f32 v30, -v33, v21, v30
  v_fma_f32 v31, v33, v20, v31
  v_mul_f32 v34, v36, v14
  v_mul_f32 v35, v36, v15
  v_fma_f32 v34, -v37, v15, v34
  s_add_u32 m0, s68, 85504
  s_nop 0
  buffer_load_dwordx4 v5, s[48:51], s66 offen lds
  v_fma_f32 v35, v37, v14, v35
  v_cvt_pk_bf16_f32 v84, v40, -v41
  v_cvt_pk_bf16_f32 v98, v26, v27
  v_cvt_pk_bf16_f32 v114, v30, v31
  v_cvt_pk_bf16_f32 v66, v34, -v35
  v_mul_f32 v42, v40, v18
  v_mul_f32 v43, v40, v19
  v_fma_f32 v42, -v41, v19, v42
  s_add_u32 m0, s69, 98816
  s_nop 0
  buffer_load_dwordx4 v6, s[52:55], s67 offen lds
  v_fma_f32 v43, v41, v18, v43
  v_mul_f32 v28, v26, v20
  v_mul_f32 v29, v26, v21
  v_fma_f32 v28, -v27, v21, v28
  v_fma_f32 v29, v27, v20, v29
  v_mul_f32 v32, v30, v20
  v_mul_f32 v33, v30, v21
  v_fma_f32 v32, -v31, v21, v32
  s_add_u32 m0, s69, 111136
  s_nop 0
  buffer_load_dwordx4 v6, s[56:59], s67 offen lds
  v_fma_f32 v33, v31, v20, v33
  v_mul_f32 v36, v34, v14
  v_mul_f32 v37, v34, v15
  v_fma_f32 v36, -v35, v15, v36
  v_fma_f32 v37, v35, v14, v37
  v_cvt_pk_bf16_f32 v85, v42, -v43
  v_cvt_pk_bf16_f32 v99, v28, v29
  v_cvt_pk_bf16_f32 v115, v32, v33
  s_add_u32 m0, s69, 99840
  s_nop 0
  buffer_load_dwordx4 v7, s[52:55], s67 offen lds
  v_cvt_pk_bf16_f32 v67, v36, -v37
  v_mul_f32 v46, v44, v22
  v_mul_f32 v47, v44, v23
  v_fma_f32 v46, -v45, v23, v46
  v_fma_f32 v47, v45, v22, v47
  v_mul_f32 v26, v28, v20
  v_mul_f32 v27, v28, v21
  v_fma_f32 v26, -v29, v21, v26
  s_add_u32 m0, s69, 112160
  s_nop 0
  buffer_load_dwordx4 v7, s[56:59], s67 offen lds
  v_fma_f32 v27, v29, v20, v27
  v_mul_f32 v30, v32, v20
  v_mul_f32 v31, v32, v21
  v_fma_f32 v30, -v33, v21, v30
  v_fma_f32 v31, v33, v20, v31
  v_mul_f32 v34, v36, v14
  v_mul_f32 v35, v36, v15
  v_fma_f32 v34, -v37, v15, v34
  s_add_u32 m0, s69, 100864
  s_nop 0
  buffer_load_dwordx4 v8, s[52:55], s67 offen lds
  v_fma_f32 v35, v37, v14, v35
  v_cvt_pk_bf16_f32 v82, v46, -v47
  v_cvt_pk_bf16_f32 v100, v26, v27
  v_cvt_pk_bf16_f32 v116, v30, v31
  v_cvt_pk_bf16_f32 v68, v34, -v35
  v_mul_f32 v40, v46, v18
  v_mul_f32 v41, v46, v19
  v_fma_f32 v40, -v47, v19, v40
  s_add_u32 m0, s69, 113184
  s_nop 0
  buffer_load_dwordx4 v8, s[56:59], s67 offen lds
  v_fma_f32 v41, v47, v18, v41
  v_mul_f32 v28, v26, v20
  v_mul_f32 v29, v26, v21
  v_fma_f32 v28, -v27, v21, v28
  v_fma_f32 v29, v27, v20, v29
  v_mul_f32 v32, v30, v20
  v_mul_f32 v33, v30, v21
  v_fma_f32 v32, -v31, v21, v32
  v_fma_f32 v33, v31, v20, v33
  v_mul_f32 v36, v34, v14
  v_mul_f32 v37, v34, v15
  v_fma_f32 v36, -v35, v15, v36
  v_fma_f32 v37, v35, v14, v37
  v_cvt_pk_bf16_f32 v83, v40, -v41
  v_cvt_pk_bf16_f32 v101, v28, v29
  v_cvt_pk_bf16_f32 v117, v32, v33
  v_cvt_pk_bf16_f32 v69, v36, -v37
  s_waitcnt lgkmcnt(0)
  s_waitcnt vmcnt(12)
  s_barrier
  s_and_b32 s10, s2, 7
  s_lshr_b32 s11, s2, 3
  s_lshl_b32 s10, s10, 6
  s_lshl_b32 s11, s11, 1
  s_add_u32 s10, s10, s11
  s_lshl_b32 s10, s10, 7
  s_add_u32 s10, s10, 4194304
  s_lshl_b32 s11, s3, 6
  v_add_u32 v52, s11, v1
  v_lshrrev_b32 v53, 4, v52
  v_lshlrev_b32 v53, 16, v53
  v_and_b32 v52, 15, v52
  v_lshl_add_u32 v52, v52, 4, v53
  v_add_u32 v52, s10, v52
  v_add_u32 v53, 1048576, v52
  v_mov_b32 v128, -1
  v_mov_b32 v129, -1
  v_mov_b32 v130, -1
  v_mov_b32 v131, -1
  global_store_dwordx4 v52, v[128:131], s[46:47] sc1
  global_store_dwordx4 v53, v[128:131], s[46:47] sc1
  s_lshl_b32 s66, s9, 7
  s_add_u32 s66, s66, s64
  s_mul_i32 s67, s9, 176128
  s_add_u32 s67, s67, s65
  s_add_u32 s9, s9, 1
  s_and_b32 s9, s9, 7
  s_add_u32 m0, s68, 0
  s_nop 0
  buffer_load_dwordx4 v2, s[48:51], s66 offen lds
  v_cvt_pk_bf16_f32 v86, v40, -v41
  v_mul_f32 v26, v28, v20
  v_mul_f32 v27, v28, v21
  v_fma_f32 v26, -v29, v21, v26
  v_fma_f32 v27, v29, v20, v27
  v_mul_f32 v30, v32, v20
  v_mul_f32 v31, v32, v21
  v_fma_f32 v30, -v33, v21, v30
  s_add_u32 m0, s68, 1024
  s_nop 0
  buffer_load_dwordx4 v3, s[48:51], s66 offen lds
  v_fma_f32 v31, v33, v20, v31
  v_mul_f32 v34, v36, v14
  v_mul_f32 v35, v36, v15
  v_fma_f32 v34, -v37, v15, v34
  v_fma_f32 v35, v37, v14, v35
  v_mul_f32 v42, v40, v18
  v_mul_f32 v43, v40, v19
  v_fma_f32 v42, -v41, v19, v42
  s_add_u32 m0, s68, 2048
  s_nop 0
  buffer_load_dwordx4 v4, s[48:51], s66 offen lds
  v_fma_f32 v43, v41, v18, v43
  v_cvt_pk_bf16_f32 v102, v26, v27
  v_cvt_pk_bf16_f32 v118, v30, v31
  v_cvt_pk_bf16_f32 v70, v34, -v35
  v_cvt_pk_bf16_f32 v87, v42, -v43
  v_mul_f32 v28, v26, v20
  v_mul_f32 v29, v26, v21
  v_fma_f32 v28, -v27, v21, v28
  s_add_u32 m0, s68, 3072
  s_nop 0
  buffer_load_dwordx4 v5, s[48:51], s66 offen lds
  v_fma_f32 v29, v27, v20, v29
  v_mul_f32 v32, v30, v20
  v_mul_f32 v33, v30, v21
  v_fma_f32 v32, -v31, v21, v32
  v_fma_f32 v33, v31, v20, v33
  v_mul_f32 v36, v34, v14
  v_mul_f32 v37, v34, v15
  v_fma_f32 v36, -v35, v15, v36
  s_add_u32 m0, s69, 16384
  s_nop 0
  buffer_load_dwordx4 v6, s[52:55], s67 offen lds
  v_fma_f32 v37, v35, v14, v37
  v_mul_f32 v44, v46, v22
  v_mul_f32 v45, v46, v23
  v_fma_f32 v44, -v47, v23, v44
  v_fma_f32 v45, v47, v22, v45
  v_cvt_pk_bf16_f32 v103, v28, v29
  v_cvt_pk_bf16_f32 v119, v32, v33
  v_cvt_pk_bf16_f32 v71, v36, -v37
  s_add_u32 m0, s69, 28704
  s_nop 0
  buffer_load_dwordx4 v6, s[56:59], s67 offen lds
  v_cvt_pk_bf16_f32 v88, v44, -v45
  v_mul_f32 v26, v28, v20
  v_mul_f32 v27, v28, v21
  v_fma_f32 v26, -v29, v21, v26
  v_fma_f32 v27, v29, v20, v27
  v_mul_f32 v30, v32, v20
  v_mul_f32 v31, v32, v21
  v_fma_f32 v30, -v33, v21, v30
  s_add_u32 m0, s69, 17408
  s_nop 0
  buffer_load_dwordx4 v7, s[52:55], s67 offen lds
  v_fma_f32 v31, v33, v20, v31
  v_cvt_pk_bf16_f32 v72, v38, -v39
  v_mul_f32 v40, v44, v20
  v_mul_f32 v41, v44, v21
  v_fma_f32 v40, -v45, v21, v40
  v_fma_f32 v41, v45, v20, v41
  v_cvt_pk_bf16_f32 v104, v26, v27
  v_cvt_pk_bf16_f32 v120, v30, v31
  s_add_u32 m0, s69, 29728
  s_nop 0
  buffer_load_dwordx4 v7, s[56:59], s67 offen lds
  v_mul_f32 v34, v38, v16
  v_mul_f32 v35, v38, v17
  v_fma_f32 v34, -v39, v17, v34
  v_fma_f32 v35, v39, v16, v35
  v_cvt_pk_bf16_f32 v92, v40, -v41
  v_mul_f32 v28, v26, v20
  v_mul_f32 v29, v26, v21
  v_fma_f32 v28, -v27, v21, v28
  s_add_u32 m0, s69, 18432
  s_nop 0
  buffer_load_dwordx4 v8, s[52:55], s67 offen lds
  v_fma_f32 v29, v27, v20, v29
  v_mul_f32 v32, v30, v20
  v_mul_f32 v33, v30, v21
  v_fma_f32 v32, -v31, v21, v32
  v_fma_f32 v33, v31, v20, v33
  v_cvt_pk_bf16_f32 v73, v34, -v35
  v_mul_f32 v46, v44, v22
  v_mul_f32 v47, v44, v23
  s_add_u32 m0, s69, 30752
  s_nop 0
  buffer_load_dwordx4 v8, s[56:59], s67 offen lds
  v_fma_f32 v46, -v45, v23, v46
  v_fma_f32 v47, v45, v22, v47
  v_cvt_pk_bf16_f32 v105, v28, v29
  v_cvt_pk_bf16_f32 v121, v32, v33
  v_mul_f32 v36, v34, v16
  v_mul_f32 v37, v34, v17
  v_fma_f32 v36, -v35, v17, v36
  v_fma_f32 v37, v35, v16, v37
  v_cvt_pk_bf16_f32 v89, v46, -v47
  v_mul_f32 v26, v28, v20
  v_mul_f32 v27, v28, v21
  v_fma_f32 v26, -v29, v21, v26
  v_fma_f32 v27, v29, v20, v27
  v_mul_f32 v30, v32, v20
  v_mul_f32 v31, v32, v21
  v_fma_f32 v30, -v33, v21, v30
  v_fma_f32 v31, v33, v20, v31
  s_waitcnt lgkmcnt(0)
  s_waitcnt vmcnt(12)
  s_barrier
  s_lshl_b32 s66, s9, 7
  s_add_u32 s66, s66, s64
  s_mul_i32 s67, s9, 176128
  s_add_u32 s67, s67, s65
  s_add_u32 s9, s9, 1
  s_and_b32 s9, s9, 7
  s_add_u32 m0, s68, 41216
  s_nop 0
  buffer_load_dwordx4 v2, s[48:51], s66 offen lds
  v_cvt_pk_bf16_f32 v74, v36, -v37
  v_mul_f32 v42, v46, v20
  v_mul_f32 v43, v46, v21
  v_fma_f32 v42, -v47, v21, v42
  v_fma_f32 v43, v47, v20, v43
  v_cvt_pk_bf16_f32 v106, v26, v27
  v_cvt_pk_bf16_f32 v122, v30, v31
  v_cvt_pk_bf16_f32 v76, v36, -v37
  s_add_u32 m0, s68, 42240
  s_nop 0
  buffer_load_dwordx4 v3, s[48:51], s66 offen lds
  v_cvt_pk_bf16_f32 v93, v42, -v43
  v_mul_f32 v28, v26, v20
  v_mul_f32 v29, v26, v21
  v_fma_f32 v28, -v27, v21, v28
  v_fma_f32 v29, v27, v20, v29
  v_mul_f32 v32, v30, v20
  v_mul_f32 v33, v30, v21
  v_fma_f32 v32, -v31, v21, v32
  s_add_u32 m0, s68, 43264
  s_nop 0
  buffer_load_dwordx4 v4, s[48:51], s66 offen lds
  v_fma_f32 v33, v31, v20, v33
  v_mul_f32 v34, v36, v16
  v_mul_f32 v35, v36, v17
  v_fma_f32 v34, -v37, v17, v34
  v_fma_f32 v35, v37, v16, v35
  v_mul_f32 v44, v46, v22
  v_mul_f32 v45, v46, v23
  v_fma_f32 v44, -v47, v23, v44
  s_add_u32 m0, s68, 44288
  s_nop 0
  buffer_load_dwordx4 v5, s[48:51], s66 offen lds
  v_fma_f32 v45, v47, v22, v45
  v_cvt_pk_bf16_f32 v107, v28, v29
  v_cvt_pk_bf16_f32 v123, v32, v33
  v_cvt_pk_bf16_f32 v77, v34, -v35
  v_cvt_pk_bf16_f32 v90, v44, -v45
  v_mul_f32 v26, v28, v20
  v_mul_f32 v27, v28, v21
  v_fma_f32 v26, -v29, v21, v26
  s_add_u32 m0, s69, 57600
  s_nop 0
  buffer_load_dwordx4 v6, s[52:55], s67 offen lds
  v_fma_f32 v27, v29, v20, v27
  v_mul_f32 v30, v32, v20
  v_mul_f32 v31, v32, v21
  v_fma_f32 v30, -v33, v21, v30
  v_fma_f32 v31, v33, v20, v31
  v_mul_f32 v36, v34, v16
  v_mul_f32 v37, v34, v17
  v_fma_f32 v36, -v35, v17, v36
  s_add_u32 m0, s69, 69920
  s_nop 0
  buffer_load_dwordx4 v6, s[56:59], s67 offen lds
  v_fma_f32 v37, v35, v16, v37
  v_mul_f32 v40, v44, v20
  v_mul_f32 v41, v44, v21
  v_fma_f32 v40, -v45, v21, v40
  v_fma_f32 v41, v45, v20, v41
  v_cvt_pk_bf16_f32 v108, v26, v27
  v_cvt_pk_bf16_f32 v124, v30, v31
  v_cvt_pk_bf16_f32 v78, v36, -v37
  s_add_u32 m0, s69, 58624
  s_nop 0
  buffer_load_dwordx4 v7, s[52:55], s67 offen lds
  v_cvt_pk_bf16_f32 v94, v40, -v41
  v_mul_f32 v28, v26, v20
  v_mul_f32 v29, v26, v21
  v_fma_f32 v28, -v27, v21, v28
  v_fma_f32 v29, v27, v20, v29
  v_mul_f32 v32, v30, v20
  v_mul_f32 v33, v30, v21
  v_fma_f32 v32, -v31, v21, v32
  s_add_u32 m0, s69, 70944
  s_nop 0
  buffer_load_dwordx4 v7, s[56:59], s67 offen lds
  v_fma_f32 v33, v31, v20, v33
  v_mul_f32 v46, v44, v22
  v_mul_f32 v47, v44, v23
  v_fma_f32 v46, -v45, v23, v46
  v_fma_f32 v47, v45, v22, v47
  v_cvt_pk_bf16_f32 v109, v28, v29
  v_cvt_pk_bf16_f32 v125, v32, v33
  v_cvt_pk_bf16_f32 v91, v46, -v47
  s_add_u32 m0, s69, 59648
  s_nop 0
  buffer_load_dwordx4 v8, s[52:55], s67 offen lds
  v_mul_f32 v26, v28, v20
  v_mul_f32 v27, v28, v21
  v_fma_f32 v26, -v29, v21, v26
  v_fma_f32 v27, v29, v20, v27
  v_mul_f32 v30, v32, v20
  v_mul_f32 v31, v32, v21
  v_fma_f32 v30, -v33, v21, v30
  v_fma_f32 v31, v33, v20, v31
  s_add_u32 m0, s69, 71968
  s_nop 0
  buffer_load_dwordx4 v8, s[56:59], s67 offen lds
  v_mul_f32 v42, v46, v20
  v_mul_f32 v43, v46, v21
  v_fma_f32 v42, -v47, v21, v42
  v_fma_f32 v43, v47, v20, v43
  v_cvt_pk_bf16_f32 v110, v26, v27
  v_cvt_pk_bf16_f32 v126, v30, v31
  v_cvt_pk_bf16_f32 v95, v42, -v43
  v_mul_f32 v28, v26, v20
  v_mul_f32 v29, v26, v21
  v_fma_f32 v28, -v27, v21, v28
  v_fma_f32 v29, v27, v20, v29
  v_mul_f32 v32, v30, v20
  v_mul_f32 v33, v30, v21
  v_fma_f32 v32, -v31, v21, v32
  v_fma_f32 v33, v31, v20, v33
  v_cvt_pk_bf16_f32 v111, v28, v29
  v_cvt_pk_bf16_f32 v127, v32, v33
  s_waitcnt lgkmcnt(0)
  s_waitcnt vmcnt(10)
  s_barrier
  v_lshlrev_b32 v59, 4, v1
  v_add_u32 v59, 4096, v59
  global_load_dwordx4 v[132:135], v59, s[46:47] sc1
  s_mul_i32 s10, s77, 33792
  s_lshl_b32 s11, s78, 8
  s_add_u32 s10, s10, s11
  s_add_u32 s10, s10, 82432
  v_lshl_add_u32 v58, v1, 2, s10
  ds_write_b32 v58, v64 offset:0
  ds_write_b32 v58, v65 offset:528
  ds_write_b32 v58, v66 offset:1056
  ds_write_b32 v58, v67 offset:1584
  ds_write_b32 v58, v68 offset:2112
  ds_write_b32 v58, v69 offset:2640
  ds_write_b32 v58, v70 offset:3168
  ds_write_b32 v58, v71 offset:3696
  ds_write_b32 v58, v72 offset:4224
  ds_write_b32 v58, v73 offset:4752
  ds_write_b32 v58, v74 offset:5280
  ds_write_b32 v58, v76 offset:6336
  ds_write_b32 v58, v77 offset:6864
  ds_write_b32 v58, v78 offset:7392
  ds_write_b32 v58, v80 offset:8448
  ds_write_b32 v58, v81 offset:8976
  ds_write_b32 v58, v82 offset:9504
  ds_write_b32 v58, v83 offset:10032
  ds_write_b32 v58, v84 offset:10560
  ds_write_b32 v58, v85 offset:11088
  ds_write_b32 v58, v86 offset:11616
  ds_write_b32 v58, v87 offset:12144
  ds_write_b32 v58, v88 offset:12672
  ds_write_b32 v58, v89 offset:13200
  ds_write_b32 v58, v90 offset:13728
  ds_write_b32 v58, v91 offset:14256
  ds_write_b32 v58, v92 offset:14784
  ds_write_b32 v58, v93 offset:15312
  ds_write_b32 v58, v94 offset:15840
  ds_write_b32 v58, v95 offset:16368
  s_waitcnt lgkmcnt(0)
  s_waitcnt vmcnt(1)
  s_barrier
  s_waitcnt vmcnt(0)
  s_mov_b32 s13, 0
L_poll_18:
  v_cmp_ne_u32 vcc, s14, v132
  v_cmp_ne_u32 s[74:75], s14, v133
  s_nop 0
  s_or_b64 vcc, vcc, s[74:75]
  v_cmp_ne_u32 s[74:75], s14, v134
  s_nop 0
  s_or_b64 vcc, vcc, s[74:75]
  v_cmp_ne_u32 s[74:75], s14, v135
  s_nop 0
  s_or_b64 vcc, vcc, s[74:75]
  s_nop 1
  s_cmp_eq_u64 vcc, 0
  s_cbranch_scc1 L_pollok_19
  s_add_u32 s13, s13, 1
  s_cmp_gt_u32 s13, 131072
  s_cbranch_scc1 L_pollok_19
  s_sleep 8
  global_load_dwordx4 v[132:135], v59, s[46:47] sc1
  s_waitcnt vmcnt(0)
  s_branch L_poll_18
L_pollok_19:
  s_and_b32 s10, s2, 7
  s_lshr_b32 s11, s2, 3
  s_lshl_b32 s10, s10, 6
  s_lshl_b32 s11, s11, 1
  s_add_u32 s10, s10, s11
  s_lshl_b32 s10, s10, 4
  s_lshl_b32 s11, s3, 19
  s_add_u32 s10, s10, s11
  s_add_u32 s10, s10, 1048576
  v_lshrrev_b32 v52, 1, v1
  v_lshlrev_b32 v52, 13, v52
  v_and_b32 v53, 1, v1
  v_lshl_add_u32 v52, v53, 4, v52
  v_add_u32 v52, s10, v52
  global_load_dwordx4 v[168:171], v52, s[46:47] sc1
  v_add_u32 v52, 262144, v52
  global_load_dwordx4 v[172:175], v52, s[46:47] sc1
  s_add_u32 s10, s10, 524288
  v_lshl_add_u32 v53, v53, 4, s10
  global_load_dword v160, v53, s[46:47] sc1
  ds_write_b32 v58, v96 offset:16896
  ds_write_b32 v58, v97 offset:17424
  ds_write_b32 v58, v98 offset:17952
  ds_write_b32 v58, v99 offset:18480
  ds_write_b32 v58, v100 offset:19008
  ds_write_b32 v58, v101 offset:19536
  ds_write_b32 v58, v102 offset:20064
  ds_write_b32 v58, v103 offset:20592
  ds_write_b32 v58, v104 offset:21120
  ds_write_b32 v58, v105 offset:21648
  ds_write_b32 v58, v106 offset:22176
  ds_write_b32 v58, v107 offset:22704
  ds_write_b32 v58, v108 offset:23232
  ds_write_b32 v58, v109 offset:23760
  ds_write_b32 v58, v110 offset:24288
  ds_write_b32 v58, v111 offset:24816
  ds_write_b32 v58, v112 offset:25344
  ds_write_b32 v58, v113 offset:25872
  ds_write_b32 v58, v114 offset:26400
  ds_write_b32 v58, v115 offset:26928
  ds_write_b32 v58, v116 offset:27456
  ds_write_b32 v58, v117 offset:27984
  ds_write_b32 v58, v118 offset:28512
  ds_write_b32 v58, v119 offset:29040
  ds_write_b32 v58, v120 offset:29568
  ds_write_b32 v58, v121 offset:30096
  ds_write_b32 v58, v122 offset:30624
  ds_write_b32 v58, v123 offset:31152
  ds_write_b32 v58, v124 offset:31680
  ds_write_b32 v58, v125 offset:32208
  ds_write_b32 v58, v126 offset:32736
  ds_write_b32 v58, v127 offset:33264
  v_mov_b32 v11, v167
  s_waitcnt lgkmcnt(0)
  s_barrier
  s_mov_b32 s60, s40
  s_and_b32 s61, s41, 0xffff
  s_mov_b32 s62, 1409024
  s_mov_b32 s63, 0x20000
  s_mul_i32 s81, s3, 360448
  s_lshl_b32 s10, s80, 7
  s_add_u32 s81, s81, s10
  v_lshrrev_b32 v52, 3, v1
  v_and_b32 v53, 7, v1
  v_bfe_u32 v54, v52, 1, 1
  v_lshlrev_b32 v54, 2, v54
  v_xor_b32 v53, v53, v54
  v_lshlrev_b32 v53, 4, v53
  v_lshl_add_u32 v161, v52, 10, v53
  s_mul_i32 s15, s3, 6144
  s_add_u32 s73, s81, 0
  s_add_u32 m0, s15, 0
  s_nop 0
  buffer_load_dwordx4 v161, s[60:63], s73 offen lds
  s_add_u32 s73, s73, 8192
  s_add_u32 m0, s15, 1024
  s_nop 0
  buffer_load_dwordx4 v161, s[60:63], s73 offen lds
  s_add_u32 s73, s73, 8192
  s_add_u32 m0, s15, 2048
  s_nop 0
  buffer_load_dwordx4 v161, s[60:63], s73 offen lds
  s_add_u32 s73, s73, 8192
  s_add_u32 m0, s15, 3072
  s_nop 0
  buffer_load_dwordx4 v161, s[60:63], s73 offen lds
  s_add_u32 s73, s73, 8192
  s_add_u32 m0, s15, 4096
  s_nop 0
  buffer_load_dwordx4 v161, s[60:63], s73 offen lds
  s_add_u32 s73, s73, 8192
  s_add_u32 m0, s15, 5120
  s_nop 0
  buffer_load_dwordx4 v161, s[60:63], s73 offen lds
  s_add_u32 s73, s73, 8192
  s_mul_i32 s15, s3, 10240
  s_add_u32 s73, s81, 49152
  s_add_u32 m0, s15, 41216
  s_nop 0
  buffer_load_dwordx4 v161, s[60:63], s73 offen lds
  s_add_u32 s73, s73, 8192
  s_add_u32 m0, s15, 42240
  s_nop 0
  buffer_load_dwordx4 v161, s[60:63], s73 offen lds
  s_add_u32 s73, s73, 8192
  s_add_u32 m0, s15, 43264
  s_nop 0
  buffer_load_dwordx4 v161, s[60:63], s73 offen lds
  s_add_u32 s73, s73, 8192
  s_add_u32 m0, s15, 44288
  s_nop 0
  buffer_load_dwordx4 v161, s[60:63], s73 offen lds
  s_add_u32 s73, s73, 8192
  s_add_u32 m0, s15, 45312
  s_nop 0
  buffer_load_dwordx4 v161, s[60:63], s73 offen lds
  s_add_u32 s73, s73, 8192
  s_add_u32 m0, s15, 46336
  s_nop 0
  buffer_load_dwordx4 v161, s[60:63], s73 offen lds
  s_add_u32 s73, s73, 8192
  s_add_u32 m0, s15, 47360
  s_nop 0
  buffer_load_dwordx4 v161, s[60:63], s73 offen lds
  s_add_u32 s73, s73, 8192
  s_add_u32 m0, s15, 48384
  s_nop 0
  buffer_load_dwordx4 v161, s[60:63], s73 offen lds
  s_add_u32 s73, s73, 8192
  s_add_u32 m0, s15, 49408
  s_nop 0
  buffer_load_dwordx4 v161, s[60:63], s73 offen lds
  s_add_u32 s73, s73, 8192
  s_add_u32 m0, s15, 50432
  s_nop 0
  buffer_load_dwordx4 v161, s[60:63], s73 offen lds
  s_add_u32 s73, s73, 8192
  v_and_b32 v12, 31, v1
  v_mul_u32_u24 v13, 528, v12
  v_lshrrev_b32 v14, 5, v1
  v_lshl_add_u32 v13, v14, 4, v13
  s_mul_i32 s10, s77, 33792
  s_add_u32 s10, s10, 82432
  v_add_u32 v13, s10, v13
  ds_read_b128 v[16:19], v13 offset:0
  ds_read_b128 v[20:23], v13 offset:16896
  ds_read_b128 v[24:27], v13 offset:32
  ds_read_b128 v[28:31], v13 offset:16928
  ds_read_b128 v[32:35], v13 offset:64
  ds_read_b128 v[36:39], v13 offset:16960
  ds_read_b128 v[40:43], v13 offset:96
  ds_read_b128 v[44:47], v13 offset:16992
  ds_read_b128 v[48:51], v13 offset:128
  ds_read_b128 v[52:55], v13 offset:17024
  ds_read_b128 v[56:59], v13 offset:160
  ds_read_b128 v[60:63], v13 offset:17056
  ds_read_b128 v[64:67], v13 offset:192
  ds_read_b128 v[68:71], v13 offset:17088
  ds_read_b128 v[72:75], v13 offset:224
  ds_read_b128 v[76:79], v13 offset:17120
  ds_read_b128 v[80:83], v13 offset:256
  ds_read_b128 v[84:87], v13 offset:17152
  ds_read_b128 v[88:91], v13 offset:288
  ds_read_b128 v[92:95], v13 offset:17184
  ds_read_b128 v[96:99], v13 offset:320
  ds_read_b128 v[100:103], v13 offset:17216
  ds_read_b128 v[104:107], v13 offset:352
  ds_read_b128 v[108:111], v13 offset:17248
  ds_read_b128 v[112:115], v13 offset:384
  ds_read_b128 v[116:119], v13 offset:17280
  ds_read_b128 v[120:123], v13 offset:416
  ds_read_b128 v[124:127], v13 offset:17312
  ds_read_b128 v[128:131], v13 offset:448
  ds_read_b128 v[132:135], v13 offset:17344
  ds_read_b128 v[136:139], v13 offset:480
  ds_read_b128 v[140:143], v13 offset:17376
  s_mul_i32 s10, s77, 4608
  s_add_u32 s10, s10, 150520
  v_lshlrev_b32 v12, 4, v12
  v_lshl_add_u32 v12, v14, 3, v12
  v_sub_u32 v12, s10, v12
  s_add_u32 s10, s10, 3592
  v_lshl_add_u32 v15, v1, 4, s10
  s_waitcnt lgkmcnt(0)
  v_mfma_f32_32x32x16_bf16 v[144:159], v[16:19], v[20:23], 0
  v_mfma_f32_32x32x16_bf16 v[144:159], v[24:27], v[28:31], v[144:159]
  v_mfma_f32_32x32x16_bf16 v[144:159], v[32:35], v[36:39], v[144:159]
  v_mfma_f32_32x32x16_bf16 v[144:159], v[40:43], v[44:47], v[144:159]
  v_mfma_f32_32x32x16_bf16 v[144:159], v[48:51], v[52:55], v[144:159]
  v_mfma_f32_32x32x16_bf16 v[144:159], v[56:59], v[60:63], v[144:159]
  v_mfma_f32_32x32x16_bf16 v[144:159], v[64:67], v[68:71], v[144:159]
  v_mfma_f32_32x32x16_bf16 v[144:159], v[72:75], v[76:79], v[144:159]
  v_mfma_f32_32x32x16_bf16 v[144:159], v[80:83], v[84:87], v[144:159]
  v_mfma_f32_32x32x16_bf16 v[144:159], v[88:91], v[92:95], v[144:159]
  v_mfma_f32_32x32x16_bf16 v[144:159], v[96:99], v[100:103], v[144:159]
  v_mfma_f32_32x32x16_bf16 v[144:159], v[104:107], v[108:111], v[144:159]
  v_mfma_f32_32x32x16_bf16 v[144:159], v[112:115], v[116:119], v[144:159]
  v_mfma_f32_32x32x16_bf16 v[144:159], v[120:123], v[124:127], v[144:159]
  v_mfma_f32_32x32x16_bf16 v[144:159], v[128:131], v[132:135], v[144:159]
  v_mfma_f32_32x32x16_bf16 v[144:159], v[136:139], v[140:143], v[144:159]
  v_cmp_le_u32 vcc, 32, v1
  v_and_b32 v16, 1, v1
  v_cmp_eq_u32 s[74:75], 1, v16
  v_mov_b32 v24, 0
  v_mov_b32 v25, 0
  v_mov_b32 v26, 0
  v_mov_b32 v27, 0
  s_nop 4
  s_cmp_eq_u32 s78, 0
  s_cbranch_scc0 L_ex1_20
  v_cvt_pk_bf16_f32 v20, v147, v146
  v_cvt_pk_bf16_f32 v21, v145, v144
  v_cvt_pk_bf16_f32 v22, v150, v149
  v_cvt_pk_bf16_f32 v23, v148, v148
  ds_write_b64 v12, v[20:21] offset:3584
  ds_write_b64 v12, v[22:23] offset:3072
  s_mov_b64 s[70:71], exec
  s_mov_b64 exec, 0x3fffffff
  ds_write_b128 v15, v[24:27]
  s_mov_b64 exec, s[70:71]
  s_branch L_ex2_21
L_ex1_20:
  v_mov_b32 v28, v156
  v_mov_b32 v29, v156
  v_mov_b32 v30, v157
  v_mov_b32 v31, v157
  v_mov_b32 v32, v158
  v_mov_b32 v33, v158
  v_mov_b32 v34, v159
  v_mov_b32 v35, v159
  v_cndmask_b32 v24, v152, v153, vcc
  v_cvt_pk_bf16_f32 v20, v153, v24
  v_cvt_pk_bf16_f32 v21, v152, v152
  v_cndmask_b32 v24, v154, v155, vcc
  v_cvt_pk_bf16_f32 v22, v155, v24
  v_cvt_pk_bf16_f32 v23, v154, v154
  v_permlane32_swap_b32 v28, v29
  v_permlane32_swap_b32 v30, v31
  v_permlane32_swap_b32 v32, v33
  v_permlane32_swap_b32 v34, v35
  ds_write_b64 v12, v[20:21] offset:2560
  ds_write_b64 v12, v[22:23] offset:2048
  v_cndmask_b32 v28, v28, v156, s[74:75]
  v_cndmask_b32 v30, v30, v157, s[74:75]
  v_cndmask_b32 v32, v32, v158, s[74:75]
  v_cndmask_b32 v34, v34, v159, s[74:75]
  v_cvt_pk_bf16_f32 v36, v156, v156
  v_cvt_pk_bf16_f32 v37, v156, v28
  v_cvt_pk_bf16_f32 v38, v157, v157
  v_cvt_pk_bf16_f32 v39, v157, v30
  v_cvt_pk_bf16_f32 v40, v158, v158
  v_cvt_pk_bf16_f32 v41, v158, v32
  v_cvt_pk_bf16_f32 v42, v159, v159
  v_cvt_pk_bf16_f32 v43, v159, v34
  ds_write_b64 v12, v[36:37] offset:1536
  ds_write_b64 v12, v[38:39] offset:1024
  ds_write_b64 v12, v[40:41] offset:512
  ds_write_b64 v12, v[42:43] offset:0
L_ex2_21:
  s_waitcnt vmcnt(16)
  v_add_u32 v48, 2, v1
  v_and_b32 v48, 63, v48
  v_lshlrev_b32 v48, 2, v48
  ds_bpermute_b32 v49, v48, v168
  ds_bpermute_b32 v50, v48, v172
  v_alignbit_b32 v132, v169, v168, 16
  v_alignbit_b32 v133, v170, v169, 16
  v_alignbit_b32 v134, v171, v170, 16
  v_alignbit_b32 v136, v173, v172, 16
  v_alignbit_b32 v137, v174, v173, 16
  v_alignbit_b32 v138, v175, v174, 16
  v_and_b32 v51, 1, v1
  v_mul_u32_u24 v51, 8320, v51
  v_lshrrev_b32 v48, 1, v1
  v_lshl_add_u32 v51, v48, 4, v51
  s_lshl_b32 s10, s3, 10
  s_add_u32 s10, s10, 24608
  v_cmp_gt_u32 vcc, 62, v1
  v_add_u32 v51, s10, v51
  s_waitcnt lgkmcnt(0)
  v_cndmask_b32 v49, v50, v49, vcc
  v_cndmask_b32 v50, v160, v50, vcc
  v_alignbit_b32 v135, v49, v171, 16
  v_alignbit_b32 v139, v50, v175, 16
  ds_write_b128 v51, v[168:171]
  ds_write_b128 v51, v[172:175] offset:512
  ds_write_b128 v51, v[132:135] offset:4160
  ds_write_b128 v51, v[136:139] offset:4672
  s_cmp_lg_u32 s3, 0
  s_cbranch_scc1 L_nopad_22
  v_lshlrev_b32 v48, 16, v168
  v_lshrrev_b32 v49, 3, v1
  v_mul_u32_u24 v49, 8320, v49
  v_and_b32 v50, 7, v1
  v_lshl_add_u32 v49, v50, 2, v49
  v_add_u32 v49, 24576, v49
  v_mov_b32 v50, 0
  s_mov_b64 s[70:71], exec
  s_mov_b64 exec, 0xffff
  ds_write_b32 v49, v50
  s_mov_b64 exec, 0x7f7f
  ds_write_b32 v49, v50 offset:4160
  s_mov_b64 exec, 3
  ds_write_b32 v51, v48 offset:4156
  s_mov_b64 exec, s[70:71]
L_nopad_22:
  v_and_b32 v12, 15, v1
  v_lshrrev_b32 v13, 4, v1
  v_and_b32 v14, 1, v13
  v_lshrrev_b32 v13, 1, v13
  v_lshlrev_b32 v15, 5, v13
  v_lshlrev_b32 v14, 4, v14
  v_sub_u32 v15, v15, v14
  s_lshl_b32 s12, s78, 6
  s_mul_i32 s10, s77, 4608
  s_add_u32 s10, s10, 150512
  s_add_u32 s10, s10, s12
  v_lshlrev_b32 v14, 5, v12
  v_sub_u32 v14, v15, v14
  v_add_u32 v10, s10, v14
  s_mul_i32 s10, s77, 8320
  s_add_u32 s10, s10, 24576
  s_add_u32 s10, s10, s12
  v_and_b32 v14, 1, v12
  v_cmp_eq_u32 vcc, 1, v14
  v_mov_b32 v14, 4176
  v_lshl_add_u32 v15, v12, 1, v15
  v_mov_b32 v13, 18
  v_cndmask_b32 v14, v14, v13, vcc
  v_add_u32 v15, v15, v14
  v_add_u32 v2, s10, v15
  v_add_u32 v3, 512, v2
  v_add_u32 v4, 1024, v2
  v_add_u32 v5, 1536, v2
  v_add_u32 v6, 2048, v2
  v_add_u32 v7, 2560, v2
  v_add_u32 v8, 3072, v2
  v_add_u32 v9, 3584, v2
  v_mov_b32 v12, v161
  s_waitcnt vmcnt(0)
  s_waitcnt lgkmcnt(0)
  s_barrier
  ds_read_b128 v[48:51], v10 offset:3584
  ds_read_b128 v[52:55], v10 offset:3072
  ds_read_b128 v[56:59], v10 offset:2560
  ds_read_b128 v[60:63], v10 offset:2048
  ds_read_b128 v[64:67], v10 offset:1536
  ds_read_b128 v[68:71], v10 offset:1024
  ds_read_b128 v[72:75], v10 offset:512
  ds_read_b128 v[76:79], v10 offset:0
  ds_read2_b32 v[16:17], v2 offset0:0 offset1:1
  ds_read2_b32 v[18:19], v2 offset0:2 offset1:3
  ds_read2_b32 v[20:21], v3 offset0:0 offset1:1
  ds_read2_b32 v[22:23], v3 offset0:2 offset1:3
  ds_read2_b32 v[24:25], v4 offset0:0 offset1:1
  ds_read2_b32 v[26:27], v4 offset0:2 offset1:3
  ds_read2_b32 v[28:29], v5 offset0:0 offset1:1
  ds_read2_b32 v[30:31], v5 offset0:2 offset1:3
  ds_read2_b32 v[32:33], v6 offset0:0 offset1:1
  ds_read2_b32 v[34:35], v6 offset0:2 offset1:3
  ds_read2_b32 v[36:37], v7 offset0:0 offset1:1
  ds_read2_b32 v[38:39], v7 offset0:2 offset1:3
  ds_read2_b32 v[40:41], v8 offset0:0 offset1:1
  ds_read2_b32 v[42:43], v8 offset0:2 offset1:3
  ds_read2_b32 v[44:45], v9 offset0:0 offset1:1
  ds_read2_b32 v[46:47], v9 offset0:2 offset1:3
  s_waitcnt lgkmcnt(14)
  v_mfma_f32_16x16x32_bf16 v[144:147], v[16:19], v[48:51], 0
  s_mul_i32 s15, s3, 4096
  s_add_u32 s73, s81, 262144
  s_add_u32 m0, s15, 115200
  v_mfma_f32_16x16x32_bf16 v[148:151], v[16:19], v[52:55], 0
  buffer_load_dwordx4 v12, s[60:63], s73 offen lds
  s_add_u32 s73, s73, 8192
  v_mfma_f32_16x16x32_bf16 v[152:155], v[16:19], v[56:59], 0
  v_mfma_f32_16x16x32_bf16 v[156:159], v[16:19], v[60:63], 0
  v_mfma_f32_16x16x32_bf16 v[160:163], v[16:19], v[64:67], 0
  v_mfma_f32_16x16x32_bf16 v[164:167], v[16:19], v[68:71], 0
  s_add_u32 m0, s15, 116224
  v_mfma_f32_16x16x32_bf16 v[168:171], v[16:19], v[72:75], 0
  buffer_load_dwordx4 v12, s[60:63], s73 offen lds
  s_add_u32 s73, s73, 8192
  v_mfma_f32_16x16x32_bf16 v[172:175], v[16:19], v[76:79], 0
  s_waitcnt lgkmcnt(0)
  v_mfma_f32_16x16x32_bf16 v[148:151], v[20:23], v[48:51], v[148:151]
  ds_read_b128 v[112:115], v10 offset:3712
  v_mfma_f32_16x16x32_bf16 v[152:155], v[20:23], v[52:55], v[152:155]
  ds_read_b128 v[116:119], v10 offset:3200
  v_mfma_f32_16x16x32_bf16 v[156:159], v[20:23], v[56:59], v[156:159]
  ds_read_b128 v[120:123], v10 offset:2688
  v_mfma_f32_16x16x32_bf16 v[160:163], v[20:23], v[60:63], v[160:163]
  ds_read_b128 v[124:127], v10 offset:2176
  s_add_u32 m0, s15, 117248
  v_mfma_f32_16x16x32_bf16 v[164:167], v[20:23], v[64:67], v[164:167]
  buffer_load_dwordx4 v12, s[60:63], s73 offen lds
  s_add_u32 s73, s73, 8192
  ds_read_b128 v[128:131], v10 offset:1664
  v_mfma_f32_16x16x32_bf16 v[168:171], v[20:23], v[68:71], v[168:171]
  ds_read_b128 v[132:135], v10 offset:1152
  v_mfma_f32_16x16x32_bf16 v[172:175], v[20:23], v[72:75], v[172:175]
  ds_read_b128 v[136:139], v10 offset:640
  v_mfma_f32_16x16x32_bf16 v[152:155], v[24:27], v[48:51], v[152:155]
  ds_read_b128 v[140:143], v10 offset:128
  v_mfma_f32_16x16x32_bf16 v[156:159], v[24:27], v[52:55], v[156:159]
  ds_read2_b32 v[80:81], v2 offset0:32 offset1:33
  s_add_u32 m0, s15, 118272
  v_mfma_f32_16x16x32_bf16 v[160:163], v[24:27], v[56:59], v[160:163]
  buffer_load_dwordx4 v12, s[60:63], s73 offen lds
  s_add_u32 s73, s73, 8192
  ds_read2_b32 v[82:83], v2 offset0:34 offset1:35
  v_mfma_f32_16x16x32_bf16 v[164:167], v[24:27], v[60:63], v[164:167]
  ds_read2_b32 v[84:85], v3 offset0:32 offset1:33
  v_mfma_f32_16x16x32_bf16 v[168:171], v[24:27], v[64:67], v[168:171]
  ds_read2_b32 v[86:87], v3 offset0:34 offset1:35
  v_mfma_f32_16x16x32_bf16 v[172:175], v[24:27], v[68:71], v[172:175]
  ds_read2_b32 v[88:89], v4 offset0:32 offset1:33
  v_mfma_f32_16x16x32_bf16 v[156:159], v[28:31], v[48:51], v[156:159]
  ds_read2_b32 v[90:91], v4 offset0:34 offset1:35
  v_mfma_f32_16x16x32_bf16 v[160:163], v[28:31], v[52:55], v[160:163]
  ds_read2_b32 v[92:93], v5 offset0:32 offset1:33
  s_mul_i32 s15, s3, 8192
  s_add_u32 s73, s81, 294912
  s_add_u32 m0, s15, 82432
  v_mfma_f32_16x16x32_bf16 v[164:167], v[28:31], v[56:59], v[164:167]
  buffer_load_dwordx4 v12, s[60:63], s73 offen lds
  s_add_u32 s73, s73, 8192
  ds_read2_b32 v[94:95], v5 offset0:34 offset1:35
  v_mfma_f32_16x16x32_bf16 v[168:171], v[28:31], v[60:63], v[168:171]
  ds_read2_b32 v[96:97], v6 offset0:32 offset1:33
  v_mfma_f32_16x16x32_bf16 v[172:175], v[28:31], v[64:67], v[172:175]
  ds_read2_b32 v[98:99], v6 offset0:34 offset1:35
  v_mfma_f32_16x16x32_bf16 v[160:163], v[32:35], v[48:51], v[160:163]
  ds_read2_b32 v[100:101], v7 offset0:32 offset1:33
  v_mfma_f32_16x16x32_bf16 v[164:167], v[32:35], v[52:55], v[164:167]
  ds_read2_b32 v[102:103], v7 offset0:34 offset1:35
  s_add_u32 m0, s15, 83456
  v_mfma_f32_16x16x32_bf16 v[168:171], v[32:35], v[56:59], v[168:171]
  buffer_load_dwordx4 v12, s[60:63], s73 offen lds
  s_add_u32 s73, s73, 8192
  ds_read2_b32 v[104:105], v8 offset0:32 offset1:33
  v_mfma_f32_16x16x32_bf16 v[172:175], v[32:35], v[60:63], v[172:175]
  ds_read2_b32 v[106:107], v8 offset0:34 offset1:35
  v_mfma_f32_16x16x32_bf16 v[164:167], v[36:39], v[48:51], v[164:167]
  ds_read2_b32 v[108:109], v9 offset0:32 offset1:33
  v_mfma_f32_16x16x32_bf16 v[168:171], v[36:39], v[52:55], v[168:171]
  ds_read2_b32 v[110:111], v9 offset0:34 offset1:35
  v_mfma_f32_16x16x32_bf16 v[172:175], v[36:39], v[56:59], v[172:175]
  v_mfma_f32_16x16x32_bf16 v[168:171], v[40:43], v[48:51], v[168:171]
  v_mfma_f32_16x16x32_bf16 v[172:175], v[40:43], v[52:55], v[172:175]
  v_mfma_f32_16x16x32_bf16 v[172:175], v[44:47], v[48:51], v[172:175]
  s_waitcnt lgkmcnt(0)
  v_mfma_f32_16x16x32_bf16 v[144:147], v[80:83], v[112:115], v[144:147]
  ds_read_b128 v[48:51], v10 offset:3840
  s_add_u32 m0, s15, 84480
  v_mfma_f32_16x16x32_bf16 v[148:151], v[80:83], v[116:119], v[148:151]
  buffer_load_dwordx4 v12, s[60:63], s73 offen lds
  s_add_u32 s73, s73, 8192
  ds_read_b128 v[52:55], v10 offset:3328
  v_mfma_f32_16x16x32_bf16 v[152:155], v[80:83], v[120:123], v[152:155]
  ds_read_b128 v[56:59], v10 offset:2816
  v_mfma_f32_16x16x32_bf16 v[156:159], v[80:83], v[124:127], v[156:159]
  ds_read_b128 v[60:63], v10 offset:2304
  v_mfma_f32_16x16x32_bf16 v[160:163], v[80:83], v[128:131], v[160:163]
  ds_read_b128 v[64:67], v10 offset:1792
  v_mfma_f32_16x16x32_bf16 v[164:167], v[80:83], v[132:135], v[164:167]
  ds_read_b128 v[68:71], v10 offset:1280
  s_add_u32 m0, s15, 85504
  v_mfma_f32_16x16x32_bf16 v[168:171], v[80:83], v[136:139], v[168:171]
  buffer_load_dwordx4 v12, s[60:63], s73 offen lds
  s_add_u32 s73, s73, 8192
  ds_read_b128 v[72:75], v10 offset:768
  v_mfma_f32_16x16x32_bf16 v[172:175], v[80:83], v[140:143], v[172:175]
  ds_read_b128 v[76:79], v10 offset:256
  v_mfma_f32_16x16x32_bf16 v[148:151], v[84:87], v[112:115], v[148:151]
  ds_read2_b32 v[16:17], v2 offset0:64 offset1:65
  v_mfma_f32_16x16x32_bf16 v[152:155], v[84:87], v[116:119], v[152:155]
  ds_read2_b32 v[18:19], v2 offset0:66 offset1:67
  v_mfma_f32_16x16x32_bf16 v[156:159], v[84:87], v[120:123], v[156:159]
  ds_read2_b32 v[20:21], v3 offset0:64 offset1:65
  v_mfma_f32_16x16x32_bf16 v[160:163], v[84:87], v[124:127], v[160:163]
  ds_read2_b32 v[22:23], v3 offset0:66 offset1:67
  s_add_u32 m0, s15, 86528
  v_mfma_f32_16x16x32_bf16 v[164:167], v[84:87], v[128:131], v[164:167]
  buffer_load_dwordx4 v12, s[60:63], s73 offen lds
  s_add_u32 s73, s73, 8192
  ds_read2_b32 v[24:25], v4 offset0:64 offset1:65
  v_mfma_f32_16x16x32_bf16 v[168:171], v[84:87], v[132:135], v[168:171]
  ds_read2_b32 v[26:27], v4 offset0:66 offset1:67
  v_mfma_f32_16x16x32_bf16 v[172:175], v[84:87], v[136:139], v[172:175]
  ds_read2_b32 v[28:29], v5 offset0:64 offset1:65
  v_mfma_f32_16x16x32_bf16 v[152:155], v[88:91], v[112:115], v[152:155]
  ds_read2_b32 v[30:31], v5 offset0:66 offset1:67
  v_mfma_f32_16x16x32_bf16 v[156:159], v[88:91], v[116:119], v[156:159]
  ds_read2_b32 v[32:33], v6 offset0:64 offset1:65
  s_add_u32 m0, s15, 87552
  v_mfma_f32_16x16x32_bf16 v[160:163], v[88:91], v[120:123], v[160:163]
  buffer_load_dwordx4 v12, s[60:63], s73 offen lds
  s_add_u32 s73, s73, 8192
  ds_read2_b32 v[34:35], v6 offset0:66 offset1:67
  v_mfma_f32_16x16x32_bf16 v[164:167], v[88:91], v[124:127], v[164:167]
  ds_read2_b32 v[36:37], v7 offset0:64 offset1:65
  v_mfma_f32_16x16x32_bf16 v[168:171], v[88:91], v[128:131], v[168:171]
  ds_read2_b32 v[38:39], v7 offset0:66 offset1:67
  v_mfma_f32_16x16x32_bf16 v[172:175], v[88:91], v[132:135], v[172:175]
  ds_read2_b32 v[40:41], v8 offset0:64 offset1:65
  v_mfma_f32_16x16x32_bf16 v[156:159], v[92:95], v[112:115], v[156:159]
  ds_read2_b32 v[42:43], v8 offset0:66 offset1:67
  v_mfma_f32_16x16x32_bf16 v[160:163], v[92:95], v[116:119], v[160:163]
  ds_read2_b32 v[44:45], v9 offset0:64 offset1:65
  s_add_u32 m0, s15, 88576
  v_mfma_f32_16x16x32_bf16 v[164:167], v[92:95], v[120:123], v[164:167]
  buffer_load_dwordx4 v12, s[60:63], s73 offen lds
  s_add_u32 s73, s73, 8192
  ds_read2_b32 v[46:47], v9 offset0:66 offset1:67
  v_mfma_f32_16x16x32_bf16 v[168:171], v[92:95], v[124:127], v[168:171]
  v_mfma_f32_16x16x32_bf16 v[172:175], v[92:95], v[128:131], v[172:175]
  v_mfma_f32_16x16x32_bf16 v[160:163], v[96:99], v[112:115], v[160:163]
  v_mfma_f32_16x16x32_bf16 v[164:167], v[96:99], v[116:119], v[164:167]
  s_add_u32 m0, s15, 89600
  v_mfma_f32_16x16x32_bf16 v[168:171], v[96:99], v[120:123], v[168:171]
  buffer_load_dwordx4 v12, s[60:63], s73 offen lds
  s_add_u32 s73, s73, 8192
  v_mfma_f32_16x16x32_bf16 v[172:175], v[96:99], v[124:127], v[172:175]
  v_mfma_f32_16x16x32_bf16 v[164:167], v[100:103], v[112:115], v[164:167]
  v_mfma_f32_16x16x32_bf16 v[168:171], v[100:103], v[116:119], v[168:171]
  v_mfma_f32_16x16x32_bf16 v[172:175], v[100:103], v[120:123], v[172:175]
  v_mfma_f32_16x16x32_bf16 v[168:171], v[104:107], v[112:115], v[168:171]
  v_mfma_f32_16x16x32_bf16 v[172:175], v[104:107], v[116:119], v[172:175]
  v_mfma_f32_16x16x32_bf16 v[172:175], v[108:111], v[112:115], v[172:175]
  s_waitcnt lgkmcnt(0)
  v_mfma_f32_16x16x32_bf16 v[144:147], v[16:19], v[48:51], v[144:147]
  ds_read_b128 v[112:115], v10 offset:3968
  v_mfma_f32_16x16x32_bf16 v[148:151], v[16:19], v[52:55], v[148:151]
  ds_read_b128 v[116:119], v10 offset:3456
  v_mfma_f32_16x16x32_bf16 v[152:155], v[16:19], v[56:59], v[152:155]
  ds_read_b128 v[120:123], v10 offset:2944
  v_mfma_f32_16x16x32_bf16 v[156:159], v[16:19], v[60:63], v[156:159]
  ds_read_b128 v[124:127], v10 offset:2432
  v_mfma_f32_16x16x32_bf16 v[160:163], v[16:19], v[64:67], v[160:163]
  ds_read_b128 v[128:131], v10 offset:1920
  v_mfma_f32_16x16x32_bf16 v[164:167], v[16:19], v[68:71], v[164:167]
  ds_read_b128 v[132:135], v10 offset:1408
  v_mfma_f32_16x16x32_bf16 v[168:171], v[16:19], v[72:75], v[168:171]
  ds_read_b128 v[136:139], v10 offset:896
  v_mfma_f32_16x16x32_bf16 v[172:175], v[16:19], v[76:79], v[172:175]
  ds_read_b128 v[140:143], v10 offset:384
  v_mfma_f32_16x16x32_bf16 v[148:151], v[20:23], v[48:51], v[148:151]
  ds_read2_b32 v[80:81], v2 offset0:96 offset1:97
  v_mfma_f32_16x16x32_bf16 v[152:155], v[20:23], v[52:55], v[152:155]
  ds_read2_b32 v[82:83], v2 offset0:98 offset1:99
  v_mfma_f32_16x16x32_bf16 v[156:159], v[20:23], v[56:59], v[156:159]
  ds_read2_b32 v[84:85], v3 offset0:96 offset1:97
  v_mfma_f32_16x16x32_bf16 v[160:163], v[20:23], v[60:63], v[160:163]
  ds_read2_b32 v[86:87], v3 offset0:98 offset1:99
  v_mfma_f32_16x16x32_bf16 v[164:167], v[20:23], v[64:67], v[164:167]
  ds_read2_b32 v[88:89], v4 offset0:96 offset1:97
  v_mfma_f32_16x16x32_bf16 v[168:171], v[20:23], v[68:71], v[168:171]
  ds_read2_b32 v[90:91], v4 offset0:98 offset1:99
  v_mfma_f32_16x16x32_bf16 v[172:175], v[20:23], v[72:75], v[172:175]
  ds_read2_b32 v[92:93], v5 offset0:96 offset1:97
  v_mfma_f32_16x16x32_bf16 v[152:155], v[24:27], v[48:51], v[152:155]
  ds_read2_b32 v[94:95], v5 offset0:98 offset1:99
  v_mfma_f32_16x16x32_bf16 v[156:159], v[24:27], v[52:55], v[156:159]
  ds_read2_b32 v[96:97], v6 offset0:96 offset1:97
  v_mfma_f32_16x16x32_bf16 v[160:163], v[24:27], v[56:59], v[160:163]
  ds_read2_b32 v[98:99], v6 offset0:98 offset1:99
  v_mfma_f32_16x16x32_bf16 v[164:167], v[24:27], v[60:63], v[164:167]
  ds_read2_b32 v[100:101], v7 offset0:96 offset1:97
  v_mfma_f32_16x16x32_bf16 v[168:171], v[24:27], v[64:67], v[168:171]
  ds_read2_b32 v[102:103], v7 offset0:98 offset1:99
  v_mfma_f32_16x16x32_bf16 v[172:175], v[24:27], v[68:71], v[172:175]
  ds_read2_b32 v[104:105], v8 offset0:96 offset1:97
  s_barrier
  v_mfma_f32_16x16x32_bf16 v[156:159], v[28:31], v[48:51], v[156:159]
  ds_read2_b32 v[106:107], v8 offset0:98 offset1:99
  v_mfma_f32_16x16x32_bf16 v[160:163], v[28:31], v[52:55], v[160:163]
  ds_read2_b32 v[108:109], v9 offset0:96 offset1:97
  v_mfma_f32_16x16x32_bf16 v[164:167], v[28:31], v[56:59], v[164:167]
  ds_read2_b32 v[110:111], v9 offset0:98 offset1:99
  v_mfma_f32_16x16x32_bf16 v[168:171], v[28:31], v[60:63], v[168:171]
  v_mfma_f32_16x16x32_bf16 v[172:175], v[28:31], v[64:67], v[172:175]
  v_mfma_f32_16x16x32_bf16 v[160:163], v[32:35], v[48:51], v[160:163]
  v_mfma_f32_16x16x32_bf16 v[164:167], v[32:35], v[52:55], v[164:167]
  v_mfma_f32_16x16x32_bf16 v[168:171], v[32:35], v[56:59], v[168:171]
  v_mfma_f32_16x16x32_bf16 v[172:175], v[32:35], v[60:63], v[172:175]
  v_mfma_f32_16x16x32_bf16 v[164:167], v[36:39], v[48:51], v[164:167]
  v_mfma_f32_16x16x32_bf16 v[168:171], v[36:39], v[52:55], v[168:171]
  v_mfma_f32_16x16x32_bf16 v[172:175], v[36:39], v[56:59], v[172:175]
  v_mfma_f32_16x16x32_bf16 v[168:171], v[40:43], v[48:51], v[168:171]
  v_mfma_f32_16x16x32_bf16 v[172:175], v[40:43], v[52:55], v[172:175]
  v_mfma_f32_16x16x32_bf16 v[172:175], v[44:47], v[48:51], v[172:175]
  s_waitcnt lgkmcnt(0)
  v_mfma_f32_16x16x32_bf16 v[144:147], v[80:83], v[112:115], v[144:147]
  v_mfma_f32_16x16x32_bf16 v[148:151], v[80:83], v[116:119], v[148:151]
  v_mfma_f32_16x16x32_bf16 v[152:155], v[80:83], v[120:123], v[152:155]
  v_mfma_f32_16x16x32_bf16 v[156:159], v[80:83], v[124:127], v[156:159]
  v_mfma_f32_16x16x32_bf16 v[160:163], v[80:83], v[128:131], v[160:163]
  v_mfma_f32_16x16x32_bf16 v[164:167], v[80:83], v[132:135], v[164:167]
  v_mfma_f32_16x16x32_bf16 v[168:171], v[80:83], v[136:139], v[168:171]
  v_mfma_f32_16x16x32_bf16 v[172:175], v[80:83], v[140:143], v[172:175]
  v_mfma_f32_16x16x32_bf16 v[148:151], v[84:87], v[112:115], v[148:151]
  v_mfma_f32_16x16x32_bf16 v[152:155], v[84:87], v[116:119], v[152:155]
  v_mfma_f32_16x16x32_bf16 v[156:159], v[84:87], v[120:123], v[156:159]
  v_mfma_f32_16x16x32_bf16 v[160:163], v[84:87], v[124:127], v[160:163]
  v_mfma_f32_16x16x32_bf16 v[164:167], v[84:87], v[128:131], v[164:167]
  v_mfma_f32_16x16x32_bf16 v[168:171], v[84:87], v[132:135], v[168:171]
  v_mfma_f32_16x16x32_bf16 v[172:175], v[84:87], v[136:139], v[172:175]
  v_mfma_f32_16x16x32_bf16 v[152:155], v[88:91], v[112:115], v[152:155]
  v_mfma_f32_16x16x32_bf16 v[156:159], v[88:91], v[116:119], v[156:159]
  v_mfma_f32_16x16x32_bf16 v[160:163], v[88:91], v[120:123], v[160:163]
  v_mfma_f32_16x16x32_bf16 v[164:167], v[88:91], v[124:127], v[164:167]
  v_mfma_f32_16x16x32_bf16 v[168:171], v[88:91], v[128:131], v[168:171]
  v_mfma_f32_16x16x32_bf16 v[172:175], v[88:91], v[132:135], v[172:175]
  v_mfma_f32_16x16x32_bf16 v[156:159], v[92:95], v[112:115], v[156:159]
  v_mfma_f32_16x16x32_bf16 v[160:163], v[92:95], v[116:119], v[160:163]
  v_mfma_f32_16x16x32_bf16 v[164:167], v[92:95], v[120:123], v[164:167]
  v_mfma_f32_16x16x32_bf16 v[168:171], v[92:95], v[124:127], v[168:171]
  v_mfma_f32_16x16x32_bf16 v[172:175], v[92:95], v[128:131], v[172:175]
  v_mfma_f32_16x16x32_bf16 v[160:163], v[96:99], v[112:115], v[160:163]
  v_mfma_f32_16x16x32_bf16 v[164:167], v[96:99], v[116:119], v[164:167]
  v_mfma_f32_16x16x32_bf16 v[168:171], v[96:99], v[120:123], v[168:171]
  v_mfma_f32_16x16x32_bf16 v[172:175], v[96:99], v[124:127], v[172:175]
  v_mfma_f32_16x16x32_bf16 v[164:167], v[100:103], v[112:115], v[164:167]
  v_mfma_f32_16x16x32_bf16 v[168:171], v[100:103], v[116:119], v[168:171]
  v_mfma_f32_16x16x32_bf16 v[172:175], v[100:103], v[120:123], v[172:175]
  v_mfma_f32_16x16x32_bf16 v[168:171], v[104:107], v[112:115], v[168:171]
  v_mfma_f32_16x16x32_bf16 v[172:175], v[104:107], v[116:119], v[172:175]
  v_mfma_f32_16x16x32_bf16 v[172:175], v[108:111], v[112:115], v[172:175]
  s_lshl_b32 s10, s3, 12
  s_add_u32 s10, s10, 131584
  v_lshl_add_u32 v2, v1, 4, s10
  s_xor_b32 s11, s3, 1
  s_lshl_b32 s11, s11, 12
  s_add_u32 s11, s11, 131584
  v_lshl_add_u32 v3, v1, 4, s11
  s_mul_i32 s10, s77, 8320
  s_add_u32 s10, s10, 24608
  s_lshl_b32 s11, s78, 11
  s_add_u32 s10, s10, s11
  v_and_b32 v4, 15, v1
  v_lshrrev_b32 v5, 4, v1
  v_lshlrev_b32 v6, 5, v4
  v_lshl_add_u32 v6, v5, 3, v6
  v_add_u32 v6, s10, v6
  s_cmp_eq_u32 s78, 0
  s_cbranch_scc1 L_cx1_23
  ds_write_b128 v2, v[144:147] offset:0
  ds_write_b128 v2, v[148:151] offset:1024
  ds_write_b128 v2, v[152:155] offset:2048
  ds_write_b128 v2, v[156:159] offset:3072
  v_pk_mul_f32 v[144:145], v[160:161], 1.0 op_sel_hi:[1,0]
  v_pk_mul_f32 v[146:147], v[162:163], 1.0 op_sel_hi:[1,0]
  v_pk_mul_f32 v[148:149], v[164:165], 1.0 op_sel_hi:[1,0]
  v_pk_mul_f32 v[150:151], v[166:167], 1.0 op_sel_hi:[1,0]
  v_pk_mul_f32 v[152:153], v[168:169], 1.0 op_sel_hi:[1,0]
  v_pk_mul_f32 v[154:155], v[170:171], 1.0 op_sel_hi:[1,0]
  v_pk_mul_f32 v[156:157], v[172:173], 1.0 op_sel_hi:[1,0]
  v_pk_mul_f32 v[158:159], v[174:175], 1.0 op_sel_hi:[1,0]
  s_branch L_cx2_24
L_cx1_23:
  ds_write_b128 v2, v[160:163] offset:0
  ds_write_b128 v2, v[164:167] offset:1024
  ds_write_b128 v2, v[168:171] offset:2048
  ds_write_b128 v2, v[172:175] offset:3072
L_cx2_24:
  ds_read_b64 v[16:17], v6 offset:0
  ds_read_b64 v[18:19], v6 offset:512
  ds_read_b64 v[20:21], v6 offset:1024
  ds_read_b64 v[22:23], v6 offset:1536
  s_lshl_b32 s10, s78, 20
  s_lshl_b32 s11, s76, 7
  s_add_u32 s10, s10, s11
  s_add_u32 s10, s10, 4194304
  v_lshrrev_b32 v7, 2, v4
  v_lshlrev_b32 v7, 16, v7
  v_and_b32 v8, 3, v4
  v_lshl_add_u32 v7, v8, 5, v7
  v_lshl_add_u32 v7, v5, 3, v7
  v_add_u32 v7, s10, v7
  s_waitcnt lgkmcnt(0)
  s_barrier
  ds_read_b128 v[64:67], v3 offset:0
  ds_read_b128 v[68:71], v3 offset:1024
  ds_read_b128 v[72:75], v3 offset:2048
  ds_read_b128 v[76:79], v3 offset:3072
  v_lshlrev_b32 v32, 16, v16
  v_and_b32 v33, 0xffff0000, v16
  v_lshlrev_b32 v34, 16, v17
  v_and_b32 v35, 0xffff0000, v17
  v_lshlrev_b32 v36, 16, v18
  v_and_b32 v37, 0xffff0000, v18
  v_lshlrev_b32 v38, 16, v19
  v_and_b32 v39, 0xffff0000, v19
  v_lshlrev_b32 v40, 16, v20
  v_and_b32 v41, 0xffff0000, v20
  v_lshlrev_b32 v42, 16, v21
  v_and_b32 v43, 0xffff0000, v21
  v_lshlrev_b32 v44, 16, v22
  v_and_b32 v45, 0xffff0000, v22
  v_lshlrev_b32 v46, 16, v23
  v_and_b32 v47, 0xffff0000, v23
  v_mov_b32 v10, v11
  v_pk_fma_f32 v[144:145], v[32:33], v[10:11], v[144:145]
  v_pk_fma_f32 v[146:147], v[34:35], v[10:11], v[146:147]
  v_pk_fma_f32 v[148:149], v[36:37], v[10:11], v[148:149]
  v_pk_fma_f32 v[150:151], v[38:39], v[10:11], v[150:151]
  v_pk_fma_f32 v[152:153], v[40:41], v[10:11], v[152:153]
  v_pk_fma_f32 v[154:155], v[42:43], v[10:11], v[154:155]
  v_pk_fma_f32 v[156:157], v[44:45], v[10:11], v[156:157]
  v_pk_fma_f32 v[158:159], v[46:47], v[10:11], v[158:159]
  s_waitcnt vmcnt(0)
  s_waitcnt lgkmcnt(0)
  s_barrier
  v_pk_add_f32 v[144:145], v[144:145], v[64:65]
  v_pk_add_f32 v[146:147], v[146:147], v[66:67]
  v_pk_add_f32 v[148:149], v[148:149], v[68:69]
  v_pk_add_f32 v[150:151], v[150:151], v[70:71]
  v_pk_add_f32 v[152:153], v[152:153], v[72:73]
  v_pk_add_f32 v[154:155], v[154:155], v[74:75]
  v_pk_add_f32 v[156:157], v[156:157], v[76:77]
  v_pk_add_f32 v[158:159], v[158:159], v[78:79]
  v_cvt_pk_bf16_f32 v16, v144, v145
  v_cvt_pk_bf16_f32 v17, v146, v147
  v_cvt_pk_bf16_f32 v18, v148, v149
  v_cvt_pk_bf16_f32 v19, v150, v151
  v_cvt_pk_bf16_f32 v20, v152, v153
  v_cvt_pk_bf16_f32 v21, v154, v155
  v_cvt_pk_bf16_f32 v22, v156, v157
  v_cvt_pk_bf16_f32 v23, v158, v159
  global_store_dwordx2 v7, v[16:17], s[46:47] sc1
  v_add_u32 v7, 262144, v7
  global_store_dwordx2 v7, v[18:19], s[46:47] sc1
  v_add_u32 v7, 262144, v7
  global_store_dwordx2 v7, v[20:21], s[46:47] sc1
  v_add_u32 v7, 262144, v7
  global_store_dwordx2 v7, v[22:23], s[46:47] sc1
  s_waitcnt vmcnt(0)
  s_endpgm

L_end:
  s_endpgm
  .fill 8448, 4, 0xbf800000
.section .rodata,"a"
.p2align 6
.amdhsa_kernel parallel_sum__ssm_conv_s4__geglu_ffn__prompt_kernel
  .amdhsa_next_free_vgpr 256
  .amdhsa_next_free_sgpr 102
  .amdhsa_accum_offset 176
  .amdhsa_group_segment_fixed_size 0
  .amdhsa_kernarg_size 128
  .amdhsa_user_sgpr_count 2
  .amdhsa_user_sgpr_kernarg_segment_ptr 1
  .amdhsa_system_sgpr_workgroup_id_x 1
  .amdhsa_float_denorm_mode_32 3
.end_amdhsa_kernel
```
